```python
import torch

def _softmax(x, axis=-1):
    return torch.softmax(x, dim=axis)
def _gelu(x):
    return torch.nn.functional.gelu(x, approximate="tanh")
def _silu(x):
    return torch.nn.functional.silu(x)
def _sigmoid(x):
    return torch.sigmoid(x)
def _layernorm(x, axis=-1, eps=1e-5):
    m = x.mean(dim=axis, keepdim=True)
    v = x.var(dim=axis, keepdim=True, unbiased=False)
    return (x - m) / torch.sqrt(v + eps)
def _scatter_add(tgt, idx, src, axis=0):
    return tgt.clone().index_add_(axis, idx, src)
def _segment_sum(src, seg, n):
    out = torch.zeros((n,) + src.shape[1:], dtype=src.dtype)
    return out.index_add_(0, seg, src)
def _pad(x, pw):
    flat = tuple(v for pair in reversed(pw) for v in pair)
    return torch.nn.functional.pad(x, flat)

kernel_name = 'concat_heads__softmax_full_mha__sliding_local_dilated__prompt'

def setup_inputs():

    _w = (lambda a: (lambda t: t.to(torch.bfloat16) if t.is_floating_point() else t)(torch.as_tensor(a)))
    def _A_setup():
        B, S, D = 1, 2048, 512
        return {
            "x": _w((lambda *s: torch.randn(*s, dtype=torch.bfloat16) * 0.2)(B, S, D)),
            "wqkv": _w((lambda *s: torch.randn(*s, dtype=torch.bfloat16) * 0.4)(D, 3 * D)),
            "wo": _w((lambda *s: torch.randn(*s, dtype=torch.bfloat16) * 0.1)(D, D)),
        }
    _A_in = _A_setup()

    def _B_setup():
        B, S, D = 1, 2048, 512
        return {
            "x": _w((lambda *s: torch.randn(*s, dtype=torch.bfloat16) * 0.4)(B, S, D)),
            "wqkv": _w((lambda *s: torch.randn(*s, dtype=torch.bfloat16) * 0.4)(D, 3 * D)),
            "wo": _w((lambda *s: torch.randn(*s, dtype=torch.bfloat16) * 0.05)(D, D)),
        }
    _B_in = _B_setup()

    return {
        "A_x": _A_in["x"],
        "A_wqkv": _A_in["wqkv"],
        "A_wo": _A_in["wo"],
        "B_x": _B_in["x"],
        "B_wqkv": _B_in["wqkv"],
        "B_wo": _B_in["wo"],
    }

def reference(A_x, A_wqkv, A_wo, B_x, B_wqkv, B_wo):
    def _A_ref(x, wqkv, wo):
        B, S, D = x.shape
        H = 32; Dh = D // H
        qkv = (lambda x, *d: x.permute(*d))((x @ wqkv).reshape(B, S, 3, H, Dh), 2, 0, 3, 1, 4)
        q, k, v = qkv[0], qkv[1], qkv[2]
        scale = Dh ** -0.5
        scores = torch.einsum("bhqd,bhkd->bhqk", q, k) * scale
        p = _softmax(scores, axis=-1)
        o = torch.einsum("bhqk,bhkd->bhqd", p, v)
        return (lambda x, *d: x.permute(*d))(o, 0, 2, 1, 3).reshape(B, S, D) @ wo

    def _B_ref(x, wqkv, wo):
        B, S, D = x.shape
        H = 32; Dh = D // H
        W, dil = 8, 2
        qkv = (lambda x, *d: x.permute(*d))((x @ wqkv).reshape(B, S, 3, H, Dh), 2, 0, 3, 1, 4)
        q, k, v = qkv[0], qkv[1], qkv[2]
        scale = Dh ** -0.5
        pos = torch.arange(S)
        off = torch.arange(W) * dil
        idx = pos[:, None] - off[None, :]
        mask = idx >= 0
        idx_c = torch.where(mask, idx, 0).reshape(-1)
        kg = k[:, :, idx_c, :].reshape(B, H, S, W, Dh)
        vg = v[:, :, idx_c, :].reshape(B, H, S, W, Dh)
        logits = torch.einsum("bhsd,bhswd->bhsw", q, kg) * scale
        logits = torch.where(mask[None, None, :, :], logits, -1e9)
        attn = _softmax(logits, axis=-1)
        o = torch.einsum("bhsw,bhswd->bhsd", attn, vg)
        return (lambda x, *d: x.permute(*d))(o, 0, 2, 1, 3).reshape(B, S, D) @ wo

    a = _A_ref(A_x, A_wqkv, A_wo)
    b = _B_ref(B_x, B_wqkv, B_wo)
    return torch.concatenate([a, b], axis=-1)
```

```asm
; @launch grid=(256,1,1) block=(512,1,1) lds=163840
.amdgcn_target "amdgcn-amd-amdhsa--gfx950"
.text
.globl concat_heads__softmax_full_mha__sliding_local_dilated__prompt_kernel
.p2align 12
.p2align 8
.type concat_heads__softmax_full_mha__sliding_local_dilated__prompt_kernel,@function
concat_heads__softmax_full_mha__sliding_local_dilated__prompt_kernel:
    s_load_dwordx16 s[4:19], s[0:1], 0
    s_load_dwordx2 s[20:21], s[0:1], 64
    s_cmp_ge_u32 s2, 256
    s_cbranch_scc1 L_end
    s_getpc_b64 s[56:57]
L_pc:
    s_and_b32 s50, s2, 0xf8
    s_lshl_b32 s50, s50, 7
    v_lshl_add_u32 v1, v0, 1, s50
    v_min_u32 v1, L_code_end-L_pc-4, v1
    s_mov_b64 exec, 1
    global_load_dword v191, v1, s[56:57]
    s_mov_b64 exec, -1
    v_readfirstlane_b32 s40, v0
    v_and_b32 v0, 63, v0
    s_lshr_b32 s43, s2, 7
    s_bfe_u32 s55, s2, 0x20005
    s_bfe_u32 s53, s2, 0x20003
    s_and_b32 s54, s2, 6
    s_lshl1_add_u32 s41, s54, s55
    s_and_b32 s54, s2, 1
    s_lshl2_add_u32 s42, s54, s53
    s_lshr_b32 s40, s40, 6
    s_and_b32 s22, s40, 3
    s_cmp_ge_u32 s40, 4
    s_cbranch_scc1 L_consumer
    s_add_u32 s61, s53, s55
    s_and_b32 s61, s61, 3
    s_lshl_b32 s61, s61, 1
    v_lshrrev_b32 v1, 3, v0
    s_and_b32 s51, s40, 1
    s_lshl_b32 s52, s51, 2
    v_lshrrev_b32 v3, 4, v0
    v_and_b32 v2, 7, v0
    v_xor_b32 v2, s52, v2
    v_xor_b32 v4, v3, v2
    v_lshlrev_b32 v4, 4, v4
    v_lshl_add_u32 v4, v1, 10, v4
    s_lshl4_add_u32 s54, s41, s40
    s_lshl_b32 s54, s54, 13
    v_add_u32 v32, s54, v4
    v_and_b32 v3, 2, v1
    v_xor_b32 v2, v3, v2
    v_mul_u32_u24 v5, 3072, v1
    v_lshl_add_u32 v5, v2, 4, v5
    s_mul_i32 s58, s40, 3072
    s_lshl_b32 s50, s42, 7
    s_lshl3_add_u32 s54, s58, s50
    v_add_u32 v34, s54, v5
    s_lshl_b32 s56, s40, 10
    s_addk_i32 s56, 2048
    s_mov_b32 s59, 0
    s_mov_b32 s60, 0
    s_mov_b32 s26, 2097152
    s_mov_b32 s27, 0x20000
    s_mov_b32 s30, 1572864
    s_mov_b32 s31, 0x20000
    s_lshl_b32 s53, s41, 17
    s_max_u32 s54, s53, 16384
    s_sub_u32 s54, s54, 16384
    s_lshl_b32 s57, s51, 10
    s_lshl3_add_u32 s54, s57, s54
    v_add_u32 v33, s54, v4
    s_addk_i32 s58, 18432
    s_lshr_b32 s70, s40, 1
    s_andn2_b32 s70, s43, s70
    s_cmp_eq_u32 s43, 0
    s_waitcnt lgkmcnt(0)
    s_mov_b64 s[24:25], s[4:5]
    s_mov_b64 s[28:29], s[6:7]
    s_cbranch_scc1 L_ld_a
    s_and_b32 s54, s2, 127
    s_cmp_eq_u32 s40, 0
    s_cbranch_scc0 L_r3x
    s_mul_i32 s54, s54, 12288
    s_addk_i32 s54, 384
    v_lshl_add_u32 v43, v0, 10, s54
    s_mov_b64 exec, 0xfff
    global_load_dword v44, v43, s[12:13]
    s_mov_b64 exec, -1
L_r3x:
    s_branch L_setup
L_b_go:
    s_add_u32 s64, s61, 1
    s_and_b32 s64, s64, 7
    s_lshl_b32 s62, s64, 7
    s_mul_i32 s63, s64, 196608
    s_lshl2_add_u32 s64, s41, s40
    s_lshl_b32 s64, s64, 15
    v_lshl_add_u32 v37, v0, 10, s64
    s_mul_i32 s64, s40, 49152
    s_lshl_b32 s65, s42, 7
    s_add_u32 s64, s64, s65
    v_lshl_add_u32 v38, v0, 10, s64
    s_cmp_lt_u32 s40, 3
    s_cbranch_scc1 L_tx
    s_mov_b32 exec_hi, 0
    buffer_load_dword v39, v37, s[24:27], s62 offen
L_tx:
    s_mov_b32 exec_hi, 0xffff
    buffer_load_dword v40, v38, s[28:31], s63 offen
    s_lshl2_add_u32 s64, s44, s40
    s_lshl_b32 s64, s64, 9
    s_add_u32 s64, s64, 10616832
    v_lshlrev_b32 v42, 7, v0
    s_mov_b64 exec, 15
    buffer_load_dword v41, v42, s[32:35], s64 offen sc1
    s_mov_b64 exec, -1
    s_mov_b64 s[24:25], s[10:11]
    s_mov_b64 s[28:29], s[12:13]
    s_branch L_b_ret
L_ld_a:
    s_lshl_b32 s62, s61, 7
    s_mul_i32 s63, s61, 196608
    s_add_u32 s64, s62, 32768
    s_add_u32 s65, s63, 98304
    s_add_u32 s66, s60, s58
    s_add_u32 m0, s60, s56
    s_nop 0
    buffer_load_dwordx4 v32, s[24:27], s62 offen lds
    s_add_u32 m0, m0, 4096
    s_nop 0
    buffer_load_dwordx4 v32, s[24:27], s64 offen lds
    s_add_u32 m0, m0, 4096
    s_add_u32 s64, s64, 32768
    buffer_load_dwordx4 v32, s[24:27], s64 offen lds
    s_add_u32 m0, m0, 4096
    s_add_u32 s64, s64, 32768
    buffer_load_dwordx4 v32, s[24:27], s64 offen lds
    s_add_u32 m0, s60, s57
    s_cmp_eq_u32 s70, 0
    s_cbranch_scc1 L_nohalo_0
    buffer_load_dwordx4 v33, s[24:27], s62 offen lds
L_nohalo_0:
    s_mov_b32 m0, s66
    s_add_u32 s61, s61, 1
    buffer_load_dwordx4 v34, s[28:31], s63 offen offset:0 lds
    buffer_load_dwordx4 v34, s[28:31], s63 offen offset:1024 lds
    buffer_load_dwordx4 v34, s[28:31], s63 offen offset:2048 lds
    s_add_u32 m0, s66, 12288
    s_and_b32 s61, s61, 7
    s_add_u32 s60, s60, 43008
    s_cmp_eq_u32 s60, 129024
    s_cselect_b32 s60, 0, s60
    s_add_u32 s59, s59, 1
    buffer_load_dwordx4 v34, s[28:31], s65 offen offset:0 lds
    buffer_load_dwordx4 v34, s[28:31], s65 offen offset:1024 lds
    buffer_load_dwordx4 v34, s[28:31], s65 offen offset:2048 lds
L_setup:
    s_mov_b32 s32, s20
    s_mov_b32 s33, s21
    s_mov_b32 s34, 14680064
    s_mov_b32 s35, 0x20000
    s_add_u32 s68, s20, 10485760
    s_addc_u32 s69, s21, 0
    s_load_dword s49, s[68:69], 0
    s_and_b32 s50, s2, 7
    s_lshr_b32 s45, s2, 5
    s_bfe_u32 s53, s2, 0x20003
    s_lshl2_add_u32 s44, s50, s53
    s_xor_b32 s44, s44, 0
    s_lshr_b32 s55, s2, 6
    s_lshl2_add_u32 s46, s50, s55
    s_bfe_u32 s47, s2, 0x30003
    s_mov_b32 s48, 0x3eb8aa3b
    v_lshlrev_b32 v14, 4, v0
    v_and_b32 v1, 59, v0
    v_cmp_eq_u32 vcc, 16, v1
    v_mov_b32 v2, 0x3afe3f80
    v_mov_b32 v3, 0
    v_cndmask_b32 v2, 0, v2, vcc
    v_mov_b32 v4, 0x3f803f80
    v_mov_b32 v5, 0
    s_nop 1
    v_mfma_f32_32x32x8_bf16 v[192:207], v[4:5], v[2:3], 0
    v_mfma_f32_32x32x8_bf16 v[208:223], v[4:5], v[2:3], 0
    v_mfma_f32_32x32x8_bf16 v[224:239], v[4:5], v[2:3], 0
    v_mfma_f32_32x32x8_bf16 v[240:255], v[4:5], v[2:3], 0
    s_and_b32 s79, s45, 1
    s_lshl_b32 s79, s79, 2
    s_xor_b32 s79, s79, s40
    s_mul_i32 s79, s79, 7168
    s_lshl_b32 s82, s45, 13
    s_lshl_b32 s83, s44, 16
    s_add_u32 s84, s83, 2097152
    s_add_u32 s81, s84, 8192
    s_add_u32 s72, s79, 0
    s_cmp_lt_u32 s72, s82
    s_cselect_b32 s80, s84, s81
    s_add_u32 s72, s72, s80
    s_add_u32 s73, s79, 1024
    s_cmp_lt_u32 s73, s82
    s_cselect_b32 s80, s84, s81
    s_add_u32 s73, s73, s80
    s_add_u32 s74, s79, 2048
    s_cmp_lt_u32 s74, s82
    s_cselect_b32 s80, s84, s81
    s_add_u32 s74, s74, s80
    s_add_u32 s75, s79, 3072
    s_cmp_lt_u32 s75, s82
    s_cselect_b32 s80, s84, s81
    s_add_u32 s75, s75, s80
    s_add_u32 s76, s79, 4096
    s_cmp_lt_u32 s76, s82
    s_cselect_b32 s80, s84, s81
    s_add_u32 s76, s76, s80
    s_add_u32 s77, s79, 5120
    s_cmp_lt_u32 s77, s82
    s_cselect_b32 s80, s84, s81
    s_add_u32 s77, s77, s80
    s_add_u32 s78, s79, 6144
    s_cmp_lt_u32 s78, s82
    s_cselect_b32 s80, s84, s81
    s_add_u32 s78, s78, s80
    s_lshl3_add_u32 s84, s45, s40
    s_lshl_b32 s84, s84, 10
    s_add_u32 s84, s84, s83
    s_add_u32 s79, s84, 2097152
    s_lshr_b32 s83, s84, 12
    s_lshl_b32 s83, s83, 9
    s_lshl2_add_u32 s83, s22, s83
    s_add_u32 s83, s83, 10747904
    v_and_b32 v15, 752, v14
    v_add_u32 v15, 2097152, v15
    s_mov_b32 s100, 0xffff
    s_mov_b32 s101, 0xffff
    s_mov_b32 s36, s16
    s_mov_b32 s37, s17
    s_mov_b32 s38, 4194304
    s_mov_b32 s39, 0x20000
    v_lshrrev_b32 v1, 3, v0
    v_and_b32 v2, 7, v0
    v_bfe_u32 v3, v1, 1, 1
    s_and_b32 s52, s40, 1
    s_lshl_b32 s52, s52, 1
    v_add_u32 v3, s52, v3
    v_lshlrev_b32 v3, 1, v3
    v_xor_b32 v3, v3, v2
    v_lshlrev_b32 v3, 4, v3
    v_lshl_add_u32 v3, v1, 10, v3
    s_and_b32 s55, s47, 1
    s_lshl_b32 s53, s55, 2
    s_xor_b32 s52, s40, s53
    s_lshl_b32 s52, s52, 13
    s_lshl_b32 s53, s47, 7
    s_add_u32 s52, s52, s53
    v_add_u32 v232, s52, v3
    s_cmp_eq_u32 s43, 0
    s_cbranch_scc0 L_b_go
L_b_ret:
    s_lshl_b32 s52, s40, 10
    s_add_u32 s67, s52, 32768
    s_lshr_b32 s85, s47, 1
    s_lshl_b32 s53, s55, 2
    s_add_u32 s85, s85, s53
    s_lshl_b32 s85, s85, 16
    v_lshrrev_b32 v2, 4, v0
    v_bfe_u32 v4, v0, 2, 2
    v_lshrrev_b32 v5, 1, v4
    v_and_b32 v6, 1, v2
    v_lshl_add_u32 v5, v6, 1, v5
    v_lshlrev_b32 v5, 5, v5
    v_lshl_add_u32 v5, v4, 7, v5
    v_and_b32 v6, 3, v0
    v_lshl_add_u32 v5, v6, 3, v5
    v_lshl_add_u32 v5, v2, 10, v5
    s_and_b32 s54, s40, 1
    s_lshr_b32 s50, s46, 2
    s_and_b32 s52, s46, 3
    s_lshl3_add_u32 s50, s50, s52
    s_andn2_b32 s52, 4, s40
    s_add_u32 s50, s50, s52
    s_bfe_u32 s52, s40, 0x10001
    s_lshl1_add_u32 s50, s50, s52
    s_lshl_b32 s52, s54, 15
    s_add_u32 s52, s52, 32768
    v_add_u32 v233, s52, v5
    s_lshl_b32 s52, s54, 6
    v_xor_b32 v233, s52, v233
    s_xor_b32 s55, s55, s54
    v_and_b32 v1, 15, v0
    v_lshlrev_b32 v5, 4, v1
    v_lshl_add_u32 v5, v2, 9, v5
    s_lshr_b32 s52, s50, 1
    s_lshl_b32 s52, s52, 15
    s_and_b32 s53, s50, 1
    s_lshl_b32 s53, s53, 8
    s_add_u32 s52, s52, s53
    s_lshl_b32 s53, s55, 14
    s_add_u32 s52, s52, s53
    s_add_u32 s52, s52, 8388608
    v_add_u32 v234, s52, v5
    v_and_b32 v5, 1, v2
    v_lshlrev_b32 v5, 5, v5
    v_lshrrev_b32 v6, 1, v2
    v_lshl_add_u32 v5, v6, 4, v5
    v_lshl_add_u32 v5, v1, 11, v5
    s_lshl_b32 s52, s50, 15
    s_lshl_b32 s53, s47, 7
    s_add_u32 s52, s52, s53
    s_lshl_b32 s53, s54, 6
    s_add_u32 s52, s52, s53
    v_add_u32 v235, s52, v5
    s_lshr_b32 s52, s50, 3
    s_lshl_b32 s52, s52, 7
    s_add_u32 s52, s52, 10493952
    v_lshl_add_u32 v5, v0, 2, s52
    s_lshr_b32 s53, s50, 1
    s_lshl1_add_u32 s53, s53, s55
    s_lshl_b32 s53, s53, 6
    s_add_u32 s53, s53, 10498048
    v_lshl_add_u32 v6, v1, 2, s53
    v_cmp_gt_u32 vcc, 32, v0
    v_mov_b32 v2, 0x3f80
    s_lshl_b32 s86, s47, 11
    v_cndmask_b32 v237, 0, v2, vcc
    v_cndmask_b32 v236, v6, v5, vcc
    s_xor_b32 s87, s86, 2048
    s_xor_b32 s88, s86, 4096
    s_xor_b32 s89, s86, 6144
    s_xor_b32 s90, s86, 8192
    s_xor_b32 s91, s86, 10240
    s_xor_b32 s92, s86, 12288
    s_xor_b32 s93, s86, 14336
    s_xor_b32 s52, s40, 7
    s_lshl3_add_u32 s53, s45, s52
    s_lshr_b32 s53, s53, 2
    s_lshl4_add_u32 s53, s44, s53
    s_lshl2_add_u32 s53, s53, 10510336
    v_mov_b32 v5, s53
    v_cmp_gt_u32 vcc, 48, v0
    s_nop 1
    v_cndmask_b32 v236, v5, v236, vcc
    s_lshl_b32 s71, s45, 3
    s_add_u32 s71, s71, s52
    s_lshl_b32 s3, s71, 7
    s_lshl2_add_u32 s3, s44, s3
    s_add_u32 s3, s3, 10498048
    s_lshl_b32 s71, s71, 15
    s_lshl_b32 s52, s44, 10
    s_add_u32 s71, s71, s52
    s_add_u32 s71, s71, 6291456
    v_mov_b32 v13, v232
    v_mov_b32 v8, v233
    v_mov_b32 v9, v234
    v_mov_b32 v10, v235
    v_mov_b32 v11, v236
    v_mov_b32 v12, v237
    v_mov_b32 v232, v238
    v_mov_b32 v233, v238
    v_mov_b32 v234, v238
    v_mov_b32 v235, v238
    v_mov_b32 v236, v238
    v_mov_b32 v237, v238
    s_lshl_b32 s52, s40, 10
    v_mov_b32 v18, v11
    v_mov_b32 v124, v12
    v_add_u32 v20, s52, v14
    v_mov_b32 v31, 0xdddd
    v_mov_b32 v126, 0
    v_mov_b32 v127, 0
    v_mov_b32 v121, 0
    v_mov_b32 v123, 0
    v_mov_b32 v125, 0
    v_mfma_f32_32x32x8_bf16 v[64:79], v[126:127], v[126:127], 0
    v_mfma_f32_32x32x8_bf16 v[80:95], v[126:127], v[126:127], 0
    v_xor_b32 v21, 1024, v20
    v_xor_b32 v22, 2048, v20
    v_xor_b32 v23, 3072, v20
    v_xor_b32 v24, 4096, v20
    v_xor_b32 v25, 5120, v20
    v_xor_b32 v26, 6144, v20
    v_xor_b32 v27, 7168, v20
    s_add_u32 s54, s71, 5242880
    s_xor_b32 s53, s40, 7
    s_lshl3_add_u32 s53, s45, s53
    s_lshr_b32 s55, s53, 2
    s_lshl4_add_u32 s55, s44, s55
    s_lshl_b32 s55, s55, 9
    s_add_u32 s55, s55, 13631488
    s_and_b32 s52, s53, 1
    s_lshl_b32 s52, s52, 8
    s_add_u32 s55, s55, s52
    s_and_b32 s53, s53, 2
    s_lshl1_add_u32 s55, s53, s55
    v_and_b32 v12, 31, v0
    v_lshlrev_b32 v12, 3, v12
    v_lshlrev_b32 v30, 3, v0
    s_and_b32 s80, s45, 1
    s_lshl_b32 s80, s80, 2
    s_xor_b32 s80, s80, s40
    s_mul_i32 s80, s80, 7
    v_add_u32 v1, s80, v0
    s_lshl_b32 s80, s45, 3
    v_cmp_le_u32 vcc, s80, v1
    v_add_u32 v5, 8, v1
    s_nop 0
    v_cndmask_b32 v1, v1, v5, vcc
    s_lshl3_add_u32 s80, s45, s40
    v_mov_b32 v5, s80
    v_cmp_gt_u32 vcc, 7, v0
    s_lshl_b32 s80, s44, 11
    s_add_u32 s80, s80, 10616832
    v_cndmask_b32 v1, v5, v1, vcc
    v_bfe_u32 v1, v1, 2, 4
    v_lshlrev_b32 v1, 7, v1
    v_and_b32 v5, 0x1f0, v14
    s_xor_b32 s81, s84, 1024
    s_xor_b32 s82, s83, 4
    s_cmp_eq_u32 s43, 0
    s_cbranch_scc1 L_c1
    s_lshl_b32 s62, s61, 7
    s_mul_i32 s63, s61, 196608
    s_add_u32 s64, s62, 32768
    s_add_u32 s65, s63, 98304
    s_add_u32 s66, s60, s58
    s_add_u32 m0, s60, s56
    s_nop 0
    buffer_load_dwordx4 v32, s[24:27], s62 offen lds
    s_add_u32 m0, m0, 4096
    s_nop 0
    buffer_load_dwordx4 v32, s[24:27], s64 offen lds
    s_add_u32 m0, m0, 4096
    s_add_u32 s64, s64, 32768
    buffer_load_dwordx4 v32, s[24:27], s64 offen lds
    s_add_u32 m0, m0, 4096
    s_add_u32 s64, s64, 32768
    buffer_load_dwordx4 v32, s[24:27], s64 offen lds
    s_add_u32 m0, s60, s57
    s_cmp_eq_u32 s70, 0
    s_cbranch_scc1 L_nohalo_b
    buffer_load_dwordx4 v33, s[24:27], s62 offen lds
L_nohalo_b:
    s_mov_b32 m0, s66
    s_add_u32 s61, s61, 1
    buffer_load_dwordx4 v34, s[28:31], s63 offen offset:0 lds
    buffer_load_dwordx4 v34, s[28:31], s63 offen offset:1024 lds
    buffer_load_dwordx4 v34, s[28:31], s63 offen offset:2048 lds
    s_add_u32 m0, s66, 12288
    s_and_b32 s61, s61, 7
    s_add_u32 s60, s60, 43008
    s_cmp_eq_u32 s60, 129024
    s_cselect_b32 s60, 0, s60
    s_add_u32 s59, s59, 1
    buffer_load_dwordx4 v34, s[28:31], s65 offen offset:0 lds
    buffer_load_dwordx4 v34, s[28:31], s65 offen offset:1024 lds
    buffer_load_dwordx4 v34, s[28:31], s65 offen offset:2048 lds
L_c1:
    s_lshl_b32 s62, s61, 7
    s_mul_i32 s63, s61, 196608
    s_add_u32 s64, s62, 32768
    s_add_u32 s65, s63, 98304
    s_add_u32 s66, s60, s58
    s_add_u32 m0, s60, s56
    s_nop 0
    buffer_load_dwordx4 v32, s[24:27], s62 offen lds
    s_add_u32 m0, m0, 4096
    s_nop 0
    buffer_load_dwordx4 v32, s[24:27], s64 offen lds
    s_add_u32 m0, m0, 4096
    s_add_u32 s64, s64, 32768
    buffer_load_dwordx4 v32, s[24:27], s64 offen lds
    s_add_u32 m0, m0, 4096
    s_add_u32 s64, s64, 32768
    buffer_load_dwordx4 v32, s[24:27], s64 offen lds
    s_add_u32 m0, s60, s57
    s_cmp_eq_u32 s70, 0
    s_cbranch_scc1 L_nohalo_e
    buffer_load_dwordx4 v33, s[24:27], s62 offen lds
L_nohalo_e:
    s_cmp_eq_u32 s70, 0
    s_cbranch_scc1 L_w_1
    s_waitcnt vmcnt(5)
    s_branch L_w_1_j
L_w_1:
    s_waitcnt vmcnt(4)
L_w_1_j:
    s_barrier
    s_mov_b32 m0, s66
    s_add_u32 s61, s61, 1
    buffer_load_dwordx4 v34, s[28:31], s63 offen offset:0 lds
    buffer_load_dwordx4 v34, s[28:31], s63 offen offset:1024 lds
    buffer_load_dwordx4 v34, s[28:31], s63 offen offset:2048 lds
    s_add_u32 m0, s66, 12288
    s_and_b32 s61, s61, 7
    s_add_u32 s60, s60, 43008
    s_cmp_eq_u32 s60, 129024
    s_cselect_b32 s60, 0, s60
    s_add_u32 s59, s59, 1
    buffer_load_dwordx4 v34, s[28:31], s65 offen offset:0 lds
    buffer_load_dwordx4 v34, s[28:31], s65 offen offset:1024 lds
    buffer_load_dwordx4 v34, s[28:31], s65 offen offset:2048 lds
    s_lshl_b32 s62, s61, 7
    s_mul_i32 s63, s61, 196608
    s_add_u32 s64, s62, 32768
    s_add_u32 s65, s63, 98304
    s_add_u32 s66, s60, s58
    s_add_u32 m0, s60, s56
    s_nop 0
    buffer_load_dwordx4 v32, s[24:27], s62 offen lds
    s_add_u32 m0, m0, 4096
    s_nop 0
    buffer_load_dwordx4 v32, s[24:27], s64 offen lds
    s_add_u32 m0, m0, 4096
    s_add_u32 s64, s64, 32768
    buffer_load_dwordx4 v32, s[24:27], s64 offen lds
    s_add_u32 m0, m0, 4096
    s_add_u32 s64, s64, 32768
    buffer_load_dwordx4 v32, s[24:27], s64 offen lds
    s_add_u32 m0, s60, s57
    s_cmp_eq_u32 s70, 0
    s_cbranch_scc1 L_nohalo_f
    buffer_load_dwordx4 v33, s[24:27], s62 offen lds
L_nohalo_f:
    s_cmp_eq_u32 s70, 0
    s_cbranch_scc1 L_w_2
    s_waitcnt vmcnt(5)
    s_branch L_w_2_j
L_w_2:
    s_waitcnt vmcnt(4)
L_w_2_j:
    s_barrier
    s_mov_b32 m0, s66
    s_add_u32 s61, s61, 1
    buffer_load_dwordx4 v34, s[28:31], s63 offen offset:0 lds
    buffer_load_dwordx4 v34, s[28:31], s63 offen offset:1024 lds
    buffer_load_dwordx4 v34, s[28:31], s63 offen offset:2048 lds
    s_add_u32 m0, s66, 12288
    s_and_b32 s61, s61, 7
    s_add_u32 s60, s60, 43008
    s_cmp_eq_u32 s60, 129024
    s_cselect_b32 s60, 0, s60
    s_add_u32 s59, s59, 1
    buffer_load_dwordx4 v34, s[28:31], s65 offen offset:0 lds
    buffer_load_dwordx4 v34, s[28:31], s65 offen offset:1024 lds
    buffer_load_dwordx4 v34, s[28:31], s65 offen offset:2048 lds
    s_lshl_b32 s62, s61, 7
    s_mul_i32 s63, s61, 196608
    s_add_u32 s64, s62, 32768
    s_add_u32 s65, s63, 98304
    s_add_u32 s66, s60, s58
    s_add_u32 m0, s60, s56
    s_nop 0
    buffer_load_dwordx4 v32, s[24:27], s62 offen lds
    s_add_u32 m0, m0, 4096
    s_nop 0
    buffer_load_dwordx4 v32, s[24:27], s64 offen lds
    s_add_u32 m0, m0, 4096
    s_add_u32 s64, s64, 32768
    buffer_load_dwordx4 v32, s[24:27], s64 offen lds
    s_add_u32 m0, m0, 4096
    s_add_u32 s64, s64, 32768
    buffer_load_dwordx4 v32, s[24:27], s64 offen lds
    s_add_u32 m0, s60, s57
    s_cmp_eq_u32 s70, 0
    s_cbranch_scc1 L_nohalo_g
    buffer_load_dwordx4 v33, s[24:27], s62 offen lds
L_nohalo_g:
    s_mov_b32 m0, s66
    s_add_u32 s61, s61, 1
    buffer_load_dwordx4 v34, s[28:31], s63 offen offset:0 lds
    buffer_load_dwordx4 v34, s[28:31], s63 offen offset:1024 lds
    buffer_load_dwordx4 v34, s[28:31], s63 offen offset:2048 lds
    s_cmp_eq_u32 s70, 0
    s_cbranch_scc1 L_w_3
    s_waitcnt vmcnt(8)
    s_branch L_w_3_j
L_w_3:
    s_waitcnt vmcnt(7)
L_w_3_j:
    s_barrier
    s_add_u32 m0, s66, 12288
    s_and_b32 s61, s61, 7
    s_add_u32 s60, s60, 43008
    s_cmp_eq_u32 s60, 129024
    s_cselect_b32 s60, 0, s60
    s_add_u32 s59, s59, 1
    buffer_load_dwordx4 v34, s[28:31], s65 offen offset:0 lds
    buffer_load_dwordx4 v34, s[28:31], s65 offen offset:1024 lds
    buffer_load_dwordx4 v34, s[28:31], s65 offen offset:2048 lds
L_ld:
    s_lshl_b32 s62, s61, 7
    s_mul_i32 s63, s61, 196608
    s_add_u32 s64, s62, 32768
    s_add_u32 s65, s63, 98304
    s_add_u32 s66, s60, s58
    s_add_u32 m0, s60, s56
    s_cmp_lt_u32 s59, 5
    s_cbranch_scc1 L_ld_go
    s_cmp_eq_u32 s70, 0
    s_cbranch_scc1 L_w_4
    s_waitcnt vmcnt(11)
    s_branch L_w_4_j
L_w_4:
    s_waitcnt vmcnt(10)
L_w_4_j:
    s_barrier
L_ld_go:
    buffer_load_dwordx4 v32, s[24:27], s62 offen lds
    s_add_u32 m0, m0, 4096
    s_nop 0
    buffer_load_dwordx4 v32, s[24:27], s64 offen lds
    s_add_u32 m0, m0, 4096
    s_add_u32 s64, s64, 32768
    buffer_load_dwordx4 v32, s[24:27], s64 offen lds
    s_add_u32 m0, m0, 4096
    s_add_u32 s64, s64, 32768
    buffer_load_dwordx4 v32, s[24:27], s64 offen lds
    s_add_u32 m0, s60, s57
    s_cmp_eq_u32 s70, 0
    s_cbranch_scc1 L_nohalo_1
    buffer_load_dwordx4 v33, s[24:27], s62 offen lds
L_nohalo_1:
    s_mov_b32 m0, s66
    s_add_u32 s61, s61, 1
    buffer_load_dwordx4 v34, s[28:31], s63 offen offset:0 lds
    buffer_load_dwordx4 v34, s[28:31], s63 offen offset:1024 lds
    buffer_load_dwordx4 v34, s[28:31], s63 offen offset:2048 lds
    s_add_u32 m0, s66, 12288
    s_and_b32 s61, s61, 7
    s_add_u32 s60, s60, 43008
    s_cmp_eq_u32 s60, 129024
    s_cselect_b32 s60, 0, s60
    s_add_u32 s59, s59, 1
    buffer_load_dwordx4 v34, s[28:31], s65 offen offset:0 lds
    buffer_load_dwordx4 v34, s[28:31], s65 offen offset:1024 lds
    buffer_load_dwordx4 v34, s[28:31], s65 offen offset:2048 lds
    s_cmp_lt_u32 s59, 8
    s_cbranch_scc1 L_ld
    s_cmp_eq_u32 s70, 0
    s_cbranch_scc1 L_w_5
    s_waitcnt vmcnt(11)
    s_branch L_w_5_j
L_w_5:
    s_waitcnt vmcnt(10)
L_w_5_j:
    s_barrier
    s_waitcnt lgkmcnt(0)
    s_mul_i32 s49, s49, 0x9e3779b1
    s_add_u32 s49, s49, 0x7f4a7c15
    s_mov_b32 s28, s14
    s_mov_b32 s29, s15
    s_mov_b32 s30, 524288
    s_mov_b32 s31, 0x20000
    s_mov_b32 m0, s67
    v_mov_b32 v16, s49
    s_waitcnt vmcnt(0)
    s_barrier
    s_setprio 3
    s_mov_b32 s23, 0
    s_mov_b32 s63, 0
    s_cmp_eq_u32 s43, 0
    s_cbranch_scc0 L_lpoll
    s_barrier
L_lpoll:
    s_mov_b32 s70, 0
L_lkvp:
    buffer_load_dword v2, v1, s[32:35], s80 offen sc1
    s_add_u32 s70, s70, 1
    s_cmp_gt_u32 s70, 65536
    s_waitcnt vmcnt(0)
    v_cmp_ne_u32 vcc, s49, v2
    s_cbranch_scc1 L_lkvp_x
    s_nop 0
    s_cbranch_vccnz L_lkvp
L_lkvp_x:
    buffer_load_dword v120, v5, s[32:35], s83 offen sc1
    buffer_load_dword v122, v5, s[32:35], s82 offen sc1
    buffer_load_dwordx4 v[116:119], v14, s[32:35], s84 offen sc1
    buffer_load_dwordx4 v[160:163], v14, s[32:35], s72 offen sc1
    buffer_load_dwordx4 v[112:115], v14, s[32:35], s81 offen sc1
    s_mov_b64 exec, s[100:101]
    buffer_load_dwordx4 v[192:195], v15, s[32:35], s72 offen offset:0 sc1
    buffer_load_dwordx4 v[196:199], v15, s[32:35], s72 offen offset:256 sc1
    s_mov_b64 exec, -1
    buffer_load_dwordx4 v[164:167], v14, s[32:35], s73 offen sc1
    s_mov_b64 exec, s[100:101]
    buffer_load_dwordx4 v[200:203], v15, s[32:35], s73 offen offset:0 sc1
    buffer_load_dwordx4 v[204:207], v15, s[32:35], s73 offen offset:256 sc1
    s_mov_b64 exec, -1
    buffer_load_dwordx4 v[168:171], v14, s[32:35], s74 offen sc1
    s_mov_b64 exec, s[100:101]
    buffer_load_dwordx4 v[208:211], v15, s[32:35], s74 offen offset:0 sc1
    buffer_load_dwordx4 v[212:215], v15, s[32:35], s74 offen offset:256 sc1
    s_mov_b64 exec, -1
    s_branch L_att_go
    .p2align 10
    .fill 183, 4, 0xbf800000
L_consumer:
    s_and_b32 s50, s2, 7
    s_lshr_b32 s45, s2, 5
    s_bfe_u32 s53, s2, 0x20003
    s_lshl2_add_u32 s44, s50, s53
    s_xor_b32 s44, s44, 0
    s_lshr_b32 s55, s2, 6
    s_lshl2_add_u32 s46, s50, s55
    s_bfe_u32 s47, s2, 0x30003
    s_mov_b32 s48, 0x3eb8aa3b
    v_lshlrev_b32 v14, 4, v0
    s_waitcnt lgkmcnt(0)
    v_and_b32 v1, 15, v0
    v_lshrrev_b32 v2, 4, v0
    v_lshrrev_b32 v3, 1, v1
    v_xor_b32 v3, v3, v2
    v_lshlrev_b32 v3, 4, v3
    v_lshl_add_u32 v8, v1, 7, v3
    v_xor_b32 v9, 64, v8
    v_bfe_u32 v4, v0, 2, 2
    v_lshrrev_b32 v5, 1, v4
    v_and_b32 v6, 1, v2
    v_lshl_add_u32 v5, v6, 1, v5
    v_xor_b32 v5, s22, v5
    v_lshlrev_b32 v5, 5, v5
    v_lshl_add_u32 v5, v4, 7, v5
    v_and_b32 v6, 3, v0
    v_lshl_add_u32 v5, v6, 3, v5
    v_mul_u32_u24 v6, 3072, v2
    v_add_u32 v10, v5, v6
    s_mov_b32 s60, 0
    v_mov_b32 v2, 0
    v_mov_b32 v3, 0
    v_add_u32 v11, s60, v8
    v_add_u32 v12, s60, v9
    v_add_u32 v13, s60, v10
    s_add_u32 s60, s60, 43008
    s_cmp_eq_u32 s60, 129024
    s_cselect_b32 s60, 0, s60
    v_mfma_f32_32x32x8_bf16 v[32:47], v[2:3], v[2:3], 0
    v_mfma_f32_32x32x8_bf16 v[48:63], v[2:3], v[2:3], 0
    v_mfma_f32_32x32x8_bf16 v[64:79], v[2:3], v[2:3], 0
    v_mfma_f32_32x32x8_bf16 v[80:95], v[2:3], v[2:3], 0
    v_mfma_f32_32x32x8_bf16 v[96:111], v[2:3], v[2:3], 0
    v_mfma_f32_32x32x8_bf16 v[112:127], v[2:3], v[2:3], 0
    v_mfma_f32_32x32x8_bf16 v[120:135], v[2:3], v[2:3], 0
    s_mov_b32 s32, s20
    s_mov_b32 s33, s21
    s_mov_b32 s34, 14680064
    s_mov_b32 s35, 0x20000
    s_add_u32 s68, s20, 10485760
    s_addc_u32 s69, s21, 0
    s_and_b32 s79, s45, 1
    s_lshl_b32 s79, s79, 2
    s_xor_b32 s79, s79, s40
    s_mul_i32 s79, s79, 7168
    s_lshl_b32 s82, s45, 13
    s_lshl_b32 s83, s44, 16
    s_add_u32 s84, s83, 2097152
    s_add_u32 s81, s84, 8192
    s_add_u32 s72, s79, 0
    s_cmp_lt_u32 s72, s82
    s_cselect_b32 s80, s84, s81
    s_add_u32 s72, s72, s80
    s_add_u32 s73, s79, 1024
    s_cmp_lt_u32 s73, s82
    s_cselect_b32 s80, s84, s81
    s_add_u32 s73, s73, s80
    s_add_u32 s74, s79, 2048
    s_cmp_lt_u32 s74, s82
    s_cselect_b32 s80, s84, s81
    s_add_u32 s74, s74, s80
    s_add_u32 s75, s79, 3072
    s_cmp_lt_u32 s75, s82
    s_cselect_b32 s80, s84, s81
    s_add_u32 s75, s75, s80
    s_add_u32 s76, s79, 4096
    s_cmp_lt_u32 s76, s82
    s_cselect_b32 s80, s84, s81
    s_add_u32 s76, s76, s80
    s_add_u32 s77, s79, 5120
    s_cmp_lt_u32 s77, s82
    s_cselect_b32 s80, s84, s81
    s_add_u32 s77, s77, s80
    s_add_u32 s78, s79, 6144
    s_cmp_lt_u32 s78, s82
    s_cselect_b32 s80, s84, s81
    s_add_u32 s78, s78, s80
    s_lshl3_add_u32 s84, s45, s40
    s_lshl_b32 s84, s84, 10
    s_add_u32 s84, s84, s83
    s_add_u32 s79, s84, 2097152
    s_lshr_b32 s83, s84, 12
    s_lshl_b32 s83, s83, 9
    s_lshl2_add_u32 s83, s22, s83
    s_add_u32 s83, s83, 10747904
    v_and_b32 v15, 752, v14
    v_add_u32 v15, 2097152, v15
    s_mov_b32 s100, 0xffff
    s_mov_b32 s101, 0xffff
    s_mov_b32 s36, s16
    s_mov_b32 s37, s17
    s_mov_b32 s38, 4194304
    s_mov_b32 s39, 0x20000
    v_lshrrev_b32 v1, 3, v0
    v_and_b32 v2, 7, v0
    v_bfe_u32 v3, v1, 1, 1
    s_and_b32 s52, s40, 1
    s_lshl_b32 s52, s52, 1
    v_add_u32 v3, s52, v3
    v_lshlrev_b32 v3, 1, v3
    v_xor_b32 v3, v3, v2
    v_lshlrev_b32 v3, 4, v3
    v_lshl_add_u32 v3, v1, 10, v3
    s_and_b32 s55, s47, 1
    s_lshl_b32 s53, s55, 2
    s_xor_b32 s52, s40, s53
    s_lshl_b32 s52, s52, 13
    s_lshl_b32 s53, s47, 7
    s_add_u32 s52, s52, s53
    v_add_u32 v232, s52, v3
    s_lshl_b32 s52, s40, 10
    s_add_u32 s67, s52, 32768
    s_lshr_b32 s85, s47, 1
    s_lshl_b32 s53, s55, 2
    s_add_u32 s85, s85, s53
    s_lshl_b32 s85, s85, 16
    v_lshrrev_b32 v2, 4, v0
    v_bfe_u32 v4, v0, 2, 2
    v_lshrrev_b32 v5, 1, v4
    v_and_b32 v6, 1, v2
    v_lshl_add_u32 v5, v6, 1, v5
    v_lshlrev_b32 v5, 5, v5
    v_lshl_add_u32 v5, v4, 7, v5
    v_and_b32 v6, 3, v0
    v_lshl_add_u32 v5, v6, 3, v5
    v_lshl_add_u32 v5, v2, 10, v5
    s_and_b32 s54, s40, 1
    s_lshr_b32 s50, s46, 2
    s_and_b32 s52, s46, 3
    s_lshl3_add_u32 s50, s50, s52
    s_andn2_b32 s52, 4, s40
    s_add_u32 s50, s50, s52
    s_bfe_u32 s52, s40, 0x10001
    s_lshl1_add_u32 s50, s50, s52
    s_lshl_b32 s52, s54, 15
    s_add_u32 s52, s52, 32768
    v_add_u32 v233, s52, v5
    s_lshl_b32 s52, s54, 6
    v_xor_b32 v233, s52, v233
    s_xor_b32 s55, s55, s54
    v_and_b32 v1, 15, v0
    v_lshlrev_b32 v5, 4, v1
    v_lshl_add_u32 v5, v2, 9, v5
    s_lshr_b32 s52, s50, 1
    s_lshl_b32 s52, s52, 15
    s_and_b32 s53, s50, 1
    s_lshl_b32 s53, s53, 8
    s_add_u32 s52, s52, s53
    s_lshl_b32 s53, s55, 14
    s_add_u32 s52, s52, s53
    s_add_u32 s52, s52, 8388608
    v_add_u32 v234, s52, v5
    v_and_b32 v5, 1, v2
    v_lshlrev_b32 v5, 5, v5
    v_lshrrev_b32 v6, 1, v2
    v_lshl_add_u32 v5, v6, 4, v5
    v_lshl_add_u32 v5, v1, 11, v5
    s_lshl_b32 s52, s50, 15
    s_lshl_b32 s53, s47, 7
    s_add_u32 s52, s52, s53
    s_lshl_b32 s53, s54, 6
    s_add_u32 s52, s52, s53
    v_add_u32 v235, s52, v5
    s_lshr_b32 s52, s50, 3
    s_lshl_b32 s52, s52, 7
    s_add_u32 s52, s52, 10493952
    v_lshl_add_u32 v5, v0, 2, s52
    s_lshr_b32 s53, s50, 1
    s_lshl1_add_u32 s53, s53, s55
    s_lshl_b32 s53, s53, 6
    s_add_u32 s53, s53, 10498048
    v_lshl_add_u32 v6, v1, 2, s53
    v_cmp_gt_u32 vcc, 32, v0
    v_mov_b32 v2, 0x3f80
    s_lshl_b32 s86, s47, 11
    v_cndmask_b32 v237, 0, v2, vcc
    v_cndmask_b32 v236, v6, v5, vcc
    s_xor_b32 s87, s86, 2048
    s_xor_b32 s88, s86, 4096
    s_xor_b32 s89, s86, 6144
    s_xor_b32 s90, s86, 8192
    s_xor_b32 s91, s86, 10240
    s_xor_b32 s92, s86, 12288
    s_xor_b32 s93, s86, 14336
    s_xor_b32 s52, s40, 7
    s_lshl3_add_u32 s53, s45, s52
    s_lshr_b32 s53, s53, 2
    s_lshl4_add_u32 s53, s44, s53
    s_lshl2_add_u32 s53, s53, 10510336
    v_mov_b32 v5, s53
    v_cmp_gt_u32 vcc, 48, v0
    s_nop 1
    v_cndmask_b32 v236, v5, v236, vcc
    s_lshl_b32 s71, s45, 3
    s_add_u32 s71, s71, s52
    s_lshl_b32 s3, s71, 7
    s_lshl2_add_u32 s3, s44, s3
    s_add_u32 s3, s3, 10498048
    s_lshl_b32 s71, s71, 15
    s_lshl_b32 s52, s44, 10
    s_add_u32 s71, s71, s52
    s_add_u32 s71, s71, 6291456
    s_cmp_eq_u32 s43, 0
    s_cbranch_scc0 L_cons_b
    s_lshl2_add_u32 s50, s42, s22
    s_lshl_b32 s51, s50, 16
    s_lshl_b32 s52, s41, 12
    s_add_u32 s51, s51, s52
    s_add_u32 s52, s51, 0
    s_xor_b32 s52, s52, s51
    s_and_b32 s52, s52, 786432
    s_xor_b32 s52, s52, s51
    s_add_u32 s53, s51, 0
    s_xor_b32 s53, s53, s51
    s_and_b32 s53, s53, 786432
    s_xor_b32 s53, s53, s51
    s_add_u32 s52, s52, 2097152
    s_add_u32 s53, s53, 4194304
    s_lshl4_add_u32 s54, s50, s41
    s_lshl_b32 s55, s54, 9
    s_add_u32 s55, s55, 10747904
    s_lshl_b32 s54, s54, 7
    s_add_u32 s54, s54, 10616832
    v_and_b32 v1, 43, v0
    v_cmp_eq_u32 vcc, 0, v1
    v_mov_b32 v6, 0x3afe3f80
    s_lshl2_add_u32 s58, s42, s22
    v_cndmask_b32 v6, 0, v6, vcc
    s_lshl4_add_u32 s63, s58, s41
    s_lshl2_add_u32 s23, s63, 10510336
    s_lshl_b32 s63, s63, 9
    s_add_u32 s63, s63, 13631488
    s_lshl_b32 s58, s58, 10
    s_lshl_b32 s50, s41, 17
    s_add_u32 s50, s50, s58
    s_add_u32 s50, s50, 11534336
    s_mov_b32 s56, -1
    s_mov_b32 s57, 0
    s_and_b32 s80, s45, 1
    s_lshl_b32 s80, s80, 2
    s_xor_b32 s80, s80, s40
    s_mul_i32 s80, s80, 7
    v_add_u32 v1, s80, v0
    s_lshl_b32 s80, s45, 3
    v_cmp_le_u32 vcc, s80, v1
    v_add_u32 v5, 8, v1
    s_nop 0
    v_cndmask_b32 v1, v1, v5, vcc
    s_lshl3_add_u32 s80, s45, s40
    v_mov_b32 v5, s80
    v_cmp_gt_u32 vcc, 7, v0
    s_lshl_b32 s80, s44, 11
    s_add_u32 s80, s80, 10616832
    v_cndmask_b32 v1, v5, v1, vcc
    v_bfe_u32 v1, v1, 2, 4
    v_lshlrev_b32 v1, 7, v1
    v_and_b32 v5, 0x1f0, v14
    s_xor_b32 s81, s84, 1024
    s_xor_b32 s82, s83, 4
    s_mov_b32 s59, 0
    s_waitcnt vmcnt(0)
    s_branch L_g0_A
L_g1_A:
    v_mfma_f32_16x16x32_bf16 v[68:71], v[224:227], v[188:191], v[68:71]
    v_mfma_f32_16x16x32_bf16 v[104:107], v[188:191], v[228:231], v[104:107]
    v_mfma_f32_16x16x32_bf16 v[32:35], v[220:223], v[188:191], v[32:35]
    v_mfma_f32_16x16x32_bf16 v[72:75], v[224:227], v[192:195], v[72:75]
    v_mfma_f32_16x16x32_bf16 v[108:111], v[192:195], v[228:231], v[108:111]
    v_mfma_f32_16x16x32_bf16 v[36:39], v[220:223], v[192:195], v[36:39]
    v_mfma_f32_16x16x32_bf16 v[76:79], v[224:227], v[196:199], v[76:79]
    v_mfma_f32_16x16x32_bf16 v[112:115], v[196:199], v[228:231], v[112:115]
    v_mfma_f32_16x16x32_bf16 v[40:43], v[220:223], v[196:199], v[40:43]
    v_mfma_f32_16x16x32_bf16 v[80:83], v[224:227], v[200:203], v[80:83]
    v_mfma_f32_16x16x32_bf16 v[116:119], v[200:203], v[228:231], v[116:119]
    v_mfma_f32_16x16x32_bf16 v[44:47], v[220:223], v[200:203], v[44:47]
    v_mfma_f32_16x16x32_bf16 v[84:87], v[224:227], v[204:207], v[84:87]
    v_mfma_f32_16x16x32_bf16 v[120:123], v[204:207], v[228:231], v[120:123]
    v_mfma_f32_16x16x32_bf16 v[48:51], v[220:223], v[204:207], v[48:51]
    v_mfma_f32_16x16x32_bf16 v[88:91], v[224:227], v[208:211], v[88:91]
    v_mfma_f32_16x16x32_bf16 v[124:127], v[208:211], v[228:231], v[124:127]
    v_mfma_f32_16x16x32_bf16 v[52:55], v[220:223], v[208:211], v[52:55]
    v_mfma_f32_16x16x32_bf16 v[92:95], v[224:227], v[212:215], v[92:95]
    v_mfma_f32_16x16x32_bf16 v[128:131], v[212:215], v[228:231], v[128:131]
    v_mfma_f32_16x16x32_bf16 v[56:59], v[220:223], v[212:215], v[56:59]
    v_mfma_f32_16x16x32_bf16 v[96:99], v[224:227], v[216:219], v[96:99]
    v_mfma_f32_16x16x32_bf16 v[132:135], v[216:219], v[228:231], v[132:135]
    v_mfma_f32_16x16x32_bf16 v[60:63], v[220:223], v[216:219], v[60:63]
L_g0_A:
    s_barrier
    ds_read_b64_tr_b16 v[176:177], v13 offset:19456
    ds_read_b64_tr_b16 v[178:179], v13 offset:19968
    ds_read_b128 v[140:143], v11 offset:2048
    ds_read_b64_tr_b16 v[180:181], v13 offset:20480
    ds_read_b64_tr_b16 v[182:183], v13 offset:20992
    ds_read_b64_tr_b16 v[172:173], v13 offset:18432
    ds_read_b64_tr_b16 v[174:175], v13 offset:18944
    ds_read_b128 v[144:147], v11 offset:4096
    ds_read_b128 v[148:151], v11 offset:6144
    ds_read_b128 v[152:155], v11 offset:8192
    ds_read_b128 v[156:159], v11 offset:10240
    ds_read_b128 v[160:163], v11 offset:12288
    ds_read_b128 v[164:167], v11 offset:14336
    ds_read_b128 v[168:171], v11 offset:16384
    s_branch L_gm_A
L_g_A:
    s_barrier
    v_mfma_f32_16x16x32_bf16 v[68:71], v[224:227], v[188:191], v[68:71]
    ds_read_b64_tr_b16 v[176:177], v13 offset:19456
    v_mfma_f32_16x16x32_bf16 v[104:107], v[188:191], v[228:231], v[104:107]
    ds_read_b64_tr_b16 v[178:179], v13 offset:19968
    v_mfma_f32_16x16x32_bf16 v[32:35], v[220:223], v[188:191], v[32:35]
    ds_read_b128 v[140:143], v11 offset:2048
    v_mfma_f32_16x16x32_bf16 v[72:75], v[224:227], v[192:195], v[72:75]
    ds_read_b64_tr_b16 v[180:181], v13 offset:20480
    v_mfma_f32_16x16x32_bf16 v[108:111], v[192:195], v[228:231], v[108:111]
    ds_read_b64_tr_b16 v[182:183], v13 offset:20992
    v_mfma_f32_16x16x32_bf16 v[36:39], v[220:223], v[192:195], v[36:39]
    ds_read_b64_tr_b16 v[172:173], v13 offset:18432
    v_mfma_f32_16x16x32_bf16 v[76:79], v[224:227], v[196:199], v[76:79]
    ds_read_b64_tr_b16 v[174:175], v13 offset:18944
    v_mfma_f32_16x16x32_bf16 v[112:115], v[196:199], v[228:231], v[112:115]
    ds_read_b128 v[144:147], v11 offset:4096
    v_mfma_f32_16x16x32_bf16 v[40:43], v[220:223], v[196:199], v[40:43]
    ds_read_b128 v[148:151], v11 offset:6144
    v_mfma_f32_16x16x32_bf16 v[80:83], v[224:227], v[200:203], v[80:83]
    ds_read_b128 v[152:155], v11 offset:8192
    v_mfma_f32_16x16x32_bf16 v[116:119], v[200:203], v[228:231], v[116:119]
    ds_read_b128 v[156:159], v11 offset:10240
    v_mfma_f32_16x16x32_bf16 v[44:47], v[220:223], v[200:203], v[44:47]
    ds_read_b128 v[160:163], v11 offset:12288
    v_mfma_f32_16x16x32_bf16 v[84:87], v[224:227], v[204:207], v[84:87]
    ds_read_b128 v[164:167], v11 offset:14336
    v_mfma_f32_16x16x32_bf16 v[120:123], v[204:207], v[228:231], v[120:123]
    ds_read_b128 v[168:171], v11 offset:16384
    v_mfma_f32_16x16x32_bf16 v[48:51], v[220:223], v[204:207], v[48:51]
    v_mfma_f32_16x16x32_bf16 v[88:91], v[224:227], v[208:211], v[88:91]
    v_mfma_f32_16x16x32_bf16 v[124:127], v[208:211], v[228:231], v[124:127]
    v_mfma_f32_16x16x32_bf16 v[52:55], v[220:223], v[208:211], v[52:55]
    v_mfma_f32_16x16x32_bf16 v[92:95], v[224:227], v[212:215], v[92:95]
    v_mfma_f32_16x16x32_bf16 v[128:131], v[212:215], v[228:231], v[128:131]
    v_mfma_f32_16x16x32_bf16 v[56:59], v[220:223], v[212:215], v[56:59]
    v_mfma_f32_16x16x32_bf16 v[96:99], v[224:227], v[216:219], v[96:99]
    v_mfma_f32_16x16x32_bf16 v[132:135], v[216:219], v[228:231], v[132:135]
    v_mfma_f32_16x16x32_bf16 v[60:63], v[220:223], v[216:219], v[60:63]
L_gm_A:
    s_waitcnt lgkmcnt(0)
    v_mfma_f32_16x16x32_bf16 v[68:71], v[176:179], v[140:143], v[68:71]
    ds_read_b64_tr_b16 v[224:225], v13 offset:31744
    v_mfma_f32_16x16x32_bf16 v[104:107], v[140:143], v[180:183], v[104:107]
    ds_read_b64_tr_b16 v[226:227], v13 offset:32256
    v_mfma_f32_16x16x32_bf16 v[32:35], v[172:175], v[140:143], v[32:35]
    ds_read_b128 v[188:191], v12 offset:2048
    v_mfma_f32_16x16x32_bf16 v[72:75], v[176:179], v[144:147], v[72:75]
    ds_read_b64_tr_b16 v[228:229], v13 offset:32768
    v_mfma_f32_16x16x32_bf16 v[108:111], v[144:147], v[180:183], v[108:111]
    ds_read_b64_tr_b16 v[230:231], v13 offset:33280
    v_mfma_f32_16x16x32_bf16 v[36:39], v[172:175], v[144:147], v[36:39]
    ds_read_b64_tr_b16 v[220:221], v13 offset:30720
    v_mfma_f32_16x16x32_bf16 v[76:79], v[176:179], v[148:151], v[76:79]
    ds_read_b64_tr_b16 v[222:223], v13 offset:31232
    v_mfma_f32_16x16x32_bf16 v[112:115], v[148:151], v[180:183], v[112:115]
    ds_read_b128 v[192:195], v12 offset:4096
    v_mfma_f32_16x16x32_bf16 v[40:43], v[172:175], v[148:151], v[40:43]
    ds_read_b128 v[196:199], v12 offset:6144
    v_mfma_f32_16x16x32_bf16 v[80:83], v[176:179], v[152:155], v[80:83]
    ds_read_b128 v[200:203], v12 offset:8192
    v_mfma_f32_16x16x32_bf16 v[116:119], v[152:155], v[180:183], v[116:119]
    ds_read_b128 v[204:207], v12 offset:10240
    v_mfma_f32_16x16x32_bf16 v[44:47], v[172:175], v[152:155], v[44:47]
    ds_read_b128 v[208:211], v12 offset:12288
    v_mfma_f32_16x16x32_bf16 v[84:87], v[176:179], v[156:159], v[84:87]
    ds_read_b128 v[212:215], v12 offset:14336
    v_mfma_f32_16x16x32_bf16 v[120:123], v[156:159], v[180:183], v[120:123]
    ds_read_b128 v[216:219], v12 offset:16384
    v_mfma_f32_16x16x32_bf16 v[48:51], v[172:175], v[156:159], v[48:51]
    v_add_u32 v11, s60, v8
    v_mfma_f32_16x16x32_bf16 v[88:91], v[176:179], v[160:163], v[88:91]
    v_add_u32 v12, s60, v9
    v_mfma_f32_16x16x32_bf16 v[124:127], v[160:163], v[180:183], v[124:127]
    v_add_u32 v13, s60, v10
    v_mfma_f32_16x16x32_bf16 v[52:55], v[172:175], v[160:163], v[52:55]
    s_add_u32 s60, s60, 43008
    v_mfma_f32_16x16x32_bf16 v[92:95], v[176:179], v[164:167], v[92:95]
    s_cmp_eq_u32 s60, 129024
    v_mfma_f32_16x16x32_bf16 v[128:131], v[164:167], v[180:183], v[128:131]
    s_cselect_b32 s60, 0, s60
    v_mfma_f32_16x16x32_bf16 v[56:59], v[172:175], v[164:167], v[56:59]
    s_sub_u32 s61, s59, 1
    v_mfma_f32_16x16x32_bf16 v[96:99], v[176:179], v[168:171], v[96:99]
    s_add_u32 s59, s59, 1
    v_mfma_f32_16x16x32_bf16 v[132:135], v[168:171], v[180:183], v[132:135]
    s_cmp_lt_u32 s61, 5
    v_mfma_f32_16x16x32_bf16 v[60:63], v[172:175], v[168:171], v[60:63]
    s_waitcnt lgkmcnt(0)
    s_cbranch_scc1 L_g_A
    s_cmp_eq_u32 s59, 1
    s_cbranch_scc1 L_g1_A
    v_mov_b32 v2, s48
    v_mov_b32 v3, s48
    s_barrier
    v_mfma_f32_16x16x32_bf16 v[68:71], v[224:227], v[188:191], v[68:71]
    ds_read_b64_tr_b16 v[176:177], v13 offset:19456
    v_mfma_f32_16x16x32_bf16 v[72:75], v[224:227], v[192:195], v[72:75]
    ds_read_b64_tr_b16 v[178:179], v13 offset:19968
    v_mfma_f32_16x16x32_bf16 v[76:79], v[224:227], v[196:199], v[76:79]
    ds_read_b128 v[140:143], v11 offset:2048
    v_mfma_f32_16x16x32_bf16 v[80:83], v[224:227], v[200:203], v[80:83]
    ds_read_b128 v[144:147], v11 offset:4096
    v_mfma_f32_16x16x32_bf16 v[84:87], v[224:227], v[204:207], v[84:87]
    ds_read_b128 v[148:151], v11 offset:6144
    v_mfma_f32_16x16x32_bf16 v[88:91], v[224:227], v[208:211], v[88:91]
    ds_read_b128 v[152:155], v11 offset:8192
    v_mfma_f32_16x16x32_bf16 v[92:95], v[224:227], v[212:215], v[92:95]
    ds_read_b128 v[156:159], v11 offset:10240
    v_mfma_f32_16x16x32_bf16 v[96:99], v[224:227], v[216:219], v[96:99]
    ds_read_b128 v[160:163], v11 offset:12288
    v_mfma_f32_16x16x32_bf16 v[32:35], v[220:223], v[188:191], v[32:35]
    ds_read_b128 v[164:167], v11 offset:14336
    v_mfma_f32_16x16x32_bf16 v[36:39], v[220:223], v[192:195], v[36:39]
    ds_read_b128 v[168:171], v11 offset:16384
    v_mfma_f32_16x16x32_bf16 v[40:43], v[220:223], v[196:199], v[40:43]
    ds_read_b64_tr_b16 v[172:173], v13 offset:18432
    v_mfma_f32_16x16x32_bf16 v[44:47], v[220:223], v[200:203], v[44:47]
    ds_read_b64_tr_b16 v[174:175], v13 offset:18944
    v_mfma_f32_16x16x32_bf16 v[48:51], v[220:223], v[204:207], v[48:51]
    ds_read_b64_tr_b16 v[180:181], v13 offset:20480
    v_mfma_f32_16x16x32_bf16 v[52:55], v[220:223], v[208:211], v[52:55]
    ds_read_b64_tr_b16 v[182:183], v13 offset:20992
    v_mfma_f32_16x16x32_bf16 v[56:59], v[220:223], v[212:215], v[56:59]
    ds_read_b64_tr_b16 v[224:225], v13 offset:31744
    v_mfma_f32_16x16x32_bf16 v[60:63], v[220:223], v[216:219], v[60:63]
    ds_read_b64_tr_b16 v[226:227], v13 offset:32256
    v_mfma_f32_16x16x32_bf16 v[104:107], v[188:191], v[228:231], v[104:107]
    ds_read_b64_tr_b16 v[220:221], v13 offset:30720
    ds_read_b64_tr_b16 v[222:223], v13 offset:31232
    v_mfma_f32_16x16x32_bf16 v[108:111], v[192:195], v[228:231], v[108:111]
    ds_read_b128 v[188:191], v12 offset:2048
    ds_read_b128 v[192:195], v12 offset:4096
    v_mfma_f32_16x16x32_bf16 v[112:115], v[196:199], v[228:231], v[112:115]
    ds_read_b128 v[196:199], v12 offset:6144
    v_mfma_f32_16x16x32_bf16 v[116:119], v[200:203], v[228:231], v[116:119]
    ds_read_b128 v[200:203], v12 offset:8192
    v_mfma_f32_16x16x32_bf16 v[120:123], v[204:207], v[228:231], v[120:123]
    ds_read_b128 v[204:207], v12 offset:10240
    v_mfma_f32_16x16x32_bf16 v[124:127], v[208:211], v[228:231], v[124:127]
    ds_read_b128 v[208:211], v12 offset:12288
    v_mfma_f32_16x16x32_bf16 v[128:131], v[212:215], v[228:231], v[128:131]
    ds_read_b128 v[212:215], v12 offset:14336
    v_mfma_f32_16x16x32_bf16 v[132:135], v[216:219], v[228:231], v[132:135]
    ds_read_b128 v[216:219], v12 offset:16384
    ds_read_b64_tr_b16 v[228:229], v13 offset:32768
    ds_read_b64_tr_b16 v[230:231], v13 offset:33280
    s_waitcnt lgkmcnt(15)
    v_mfma_f32_16x16x32_bf16 v[68:71], v[176:179], v[140:143], v[68:71]
    v_mfma_f32_16x16x32_bf16 v[72:75], v[176:179], v[144:147], v[72:75]
    v_mfma_f32_16x16x32_bf16 v[76:79], v[176:179], v[148:151], v[76:79]
    v_mfma_f32_16x16x32_bf16 v[80:83], v[176:179], v[152:155], v[80:83]
    v_mfma_f32_16x16x32_bf16 v[84:87], v[176:179], v[156:159], v[84:87]
    v_mfma_f32_16x16x32_bf16 v[88:91], v[176:179], v[160:163], v[88:91]
    v_mfma_f32_16x16x32_bf16 v[92:95], v[176:179], v[164:167], v[92:95]
    v_mfma_f32_16x16x32_bf16 v[96:99], v[176:179], v[168:171], v[96:99]
    s_waitcnt lgkmcnt(9)
    v_mfma_f32_16x16x32_bf16 v[68:71], v[224:227], v[188:191], v[68:71]
    s_waitcnt lgkmcnt(8)
    v_mfma_f32_16x16x32_bf16 v[72:75], v[224:227], v[192:195], v[72:75]
    s_waitcnt lgkmcnt(7)
    v_mfma_f32_16x16x32_bf16 v[76:79], v[224:227], v[196:199], v[76:79]
    s_waitcnt lgkmcnt(6)
    v_mfma_f32_16x16x32_bf16 v[80:83], v[224:227], v[200:203], v[80:83]
    s_waitcnt lgkmcnt(5)
    v_mfma_f32_16x16x32_bf16 v[84:87], v[224:227], v[204:207], v[84:87]
    s_waitcnt lgkmcnt(4)
    v_mfma_f32_16x16x32_bf16 v[88:91], v[224:227], v[208:211], v[88:91]
    s_waitcnt lgkmcnt(3)
    v_mfma_f32_16x16x32_bf16 v[92:95], v[224:227], v[212:215], v[92:95]
    s_waitcnt lgkmcnt(2)
    v_mfma_f32_16x16x32_bf16 v[96:99], v[224:227], v[216:219], v[96:99]
    s_waitcnt lgkmcnt(0)
    s_load_dword s49, s[68:69], 0
    v_mfma_f32_16x16x32_bf16 v[104:107], v[140:143], v[180:183], v[104:107]
    v_cvt_pk_bf16_f32 v16, v68, v69
    v_cvt_pk_bf16_f32 v17, v70, v71
    v_mfma_f32_16x16x32_bf16 v[108:111], v[144:147], v[180:183], v[108:111]
    v_cvt_pk_bf16_f32 v18, v72, v73
    v_cvt_pk_bf16_f32 v19, v74, v75
    v_mfma_f32_16x16x32_bf16 v[112:115], v[148:151], v[180:183], v[112:115]
    v_cvt_pk_bf16_f32 v20, v76, v77
    v_cvt_pk_bf16_f32 v21, v78, v79
    v_mfma_f32_16x16x32_bf16 v[116:119], v[152:155], v[180:183], v[116:119]
    v_cvt_pk_bf16_f32 v22, v80, v81
    v_cvt_pk_bf16_f32 v23, v82, v83
    v_mfma_f32_16x16x32_bf16 v[120:123], v[156:159], v[180:183], v[120:123]
    v_permlane16_swap_b32 v16, v18
    v_permlane16_swap_b32 v17, v19
    v_mfma_f32_16x16x32_bf16 v[124:127], v[160:163], v[180:183], v[124:127]
    buffer_store_dwordx4 v[16:19], v14, s[32:35], s52 offen offset:0 sc1
    v_cvt_pk_bf16_f32 v24, v84, v85
    v_mfma_f32_16x16x32_bf16 v[128:131], v[164:167], v[180:183], v[128:131]
    v_cvt_pk_bf16_f32 v25, v86, v87
    v_cvt_pk_bf16_f32 v26, v88, v89
    v_mfma_f32_16x16x32_bf16 v[132:135], v[168:171], v[180:183], v[132:135]
    v_cvt_pk_bf16_f32 v27, v90, v91
    v_permlane16_swap_b32 v20, v22
    v_mfma_f32_16x16x32_bf16 v[104:107], v[188:191], v[228:231], v[104:107]
    v_permlane16_swap_b32 v21, v23
    buffer_store_dwordx4 v[20:23], v14, s[32:35], s52 offen offset:1024 sc1
    v_mfma_f32_16x16x32_bf16 v[108:111], v[192:195], v[228:231], v[108:111]
    v_cvt_pk_bf16_f32 v28, v92, v93
    v_cvt_pk_bf16_f32 v29, v94, v95
    v_mfma_f32_16x16x32_bf16 v[112:115], v[196:199], v[228:231], v[112:115]
    v_cvt_pk_bf16_f32 v30, v96, v97
    v_cvt_pk_bf16_f32 v31, v98, v99
    v_mfma_f32_16x16x32_bf16 v[116:119], v[200:203], v[228:231], v[116:119]
    v_permlane16_swap_b32 v24, v26
    v_permlane16_swap_b32 v25, v27
    v_mfma_f32_16x16x32_bf16 v[120:123], v[204:207], v[228:231], v[120:123]
    buffer_store_dwordx4 v[24:27], v14, s[32:35], s52 offen offset:2048 sc1
    v_permlane16_swap_b32 v28, v30
    v_mfma_f32_16x16x32_bf16 v[124:127], v[208:211], v[228:231], v[124:127]
    v_permlane16_swap_b32 v29, v31
    buffer_store_dwordx4 v[28:31], v14, s[32:35], s52 offen offset:3072 sc1
    v_mfma_f32_16x16x32_bf16 v[128:131], v[212:215], v[228:231], v[128:131]
    v_mfma_f32_16x16x32_bf16 v[132:135], v[216:219], v[228:231], v[132:135]
    v_mfma_f32_16x16x32_bf16 v[32:35], v[172:175], v[140:143], v[32:35]
    v_cvt_pk_bf16_f32 v240, v104, v105
    v_cvt_pk_bf16_f32 v241, v106, v107
    v_mfma_f32_16x16x32_bf16 v[36:39], v[172:175], v[144:147], v[36:39]
    v_cvt_pk_bf16_f32 v242, v108, v109
    v_cvt_pk_bf16_f32 v243, v110, v111
    v_mfma_f32_16x16x32_bf16 v[40:43], v[172:175], v[148:151], v[40:43]
    v_cvt_pk_bf16_f32 v244, v112, v113
    v_cvt_pk_bf16_f32 v245, v114, v115
    v_mfma_f32_16x16x32_bf16 v[44:47], v[172:175], v[152:155], v[44:47]
    v_cvt_pk_bf16_f32 v246, v116, v117
    v_cvt_pk_bf16_f32 v247, v118, v119
    v_mfma_f32_16x16x32_bf16 v[48:51], v[172:175], v[156:159], v[48:51]
    v_permlane16_swap_b32 v240, v242
    v_permlane16_swap_b32 v241, v243
    v_mfma_f32_16x16x32_bf16 v[52:55], v[172:175], v[160:163], v[52:55]
    buffer_store_dwordx4 v[240:243], v14, s[32:35], s53 offen offset:0 sc1
    v_cvt_pk_bf16_f32 v248, v120, v121
    v_mfma_f32_16x16x32_bf16 v[56:59], v[172:175], v[164:167], v[56:59]
    v_cvt_pk_bf16_f32 v249, v122, v123
    v_cvt_pk_bf16_f32 v250, v124, v125
    v_mfma_f32_16x16x32_bf16 v[60:63], v[172:175], v[168:171], v[60:63]
    v_cvt_pk_bf16_f32 v251, v126, v127
    v_permlane16_swap_b32 v244, v246
    v_mfma_f32_16x16x32_bf16 v[32:35], v[220:223], v[188:191], v[32:35]
    v_permlane16_swap_b32 v245, v247
    buffer_store_dwordx4 v[244:247], v14, s[32:35], s53 offen offset:1024 sc1
    v_mfma_f32_16x16x32_bf16 v[36:39], v[220:223], v[192:195], v[36:39]
    v_cvt_pk_bf16_f32 v252, v128, v129
    v_cvt_pk_bf16_f32 v253, v130, v131
    v_mfma_f32_16x16x32_bf16 v[40:43], v[220:223], v[196:199], v[40:43]
    v_cvt_pk_bf16_f32 v254, v132, v133
    v_cvt_pk_bf16_f32 v255, v134, v135
    v_mfma_f32_16x16x32_bf16 v[44:47], v[220:223], v[200:203], v[44:47]
    v_permlane16_swap_b32 v248, v250
    v_permlane16_swap_b32 v249, v251
    v_mfma_f32_16x16x32_bf16 v[48:51], v[220:223], v[204:207], v[48:51]
    buffer_store_dwordx4 v[248:251], v14, s[32:35], s53 offen offset:2048 sc1
    v_permlane16_swap_b32 v252, v254
    v_mfma_f32_16x16x32_bf16 v[52:55], v[220:223], v[208:211], v[52:55]
    v_permlane16_swap_b32 v253, v255
    buffer_store_dwordx4 v[252:255], v14, s[32:35], s53 offen offset:3072 sc1
    v_mfma_f32_16x16x32_bf16 v[56:59], v[220:223], v[212:215], v[56:59]
    v_mfma_f32_16x16x32_bf16 v[60:63], v[220:223], v[216:219], v[60:63]
    v_pk_mul_f32 v[32:33], v[32:33], v[2:3]
    v_pk_mul_f32 v[34:35], v[34:35], v[2:3]
    v_pk_mul_f32 v[36:37], v[36:37], v[2:3]
    v_pk_mul_f32 v[38:39], v[38:39], v[2:3]
    v_cvt_pk_bf16_f32 v176, v32, v33
    v_cvt_pk_bf16_f32 v177, v34, v35
    v_cvt_pk_bf16_f32 v178, v36, v37
    v_cvt_pk_bf16_f32 v179, v38, v39
    v_pk_mul_f32 v[40:41], v[40:41], v[2:3]
    v_pk_mul_f32 v[42:43], v[42:43], v[2:3]
    v_pk_mul_f32 v[44:45], v[44:45], v[2:3]
    v_pk_mul_f32 v[46:47], v[46:47], v[2:3]
    v_cvt_pk_bf16_f32 v180, v40, v41
    v_cvt_pk_bf16_f32 v181, v42, v43
    v_cvt_pk_bf16_f32 v182, v44, v45
    v_cvt_pk_bf16_f32 v183, v46, v47
    v_permlane16_swap_b32 v176, v178
    v_permlane16_swap_b32 v177, v179
    buffer_store_dwordx4 v[176:179], v14, s[32:35], s51 offen offset:0 sc1
    s_nop 0
    v_mfma_f32_32x32x16_bf16 v[64:79], v[16:19], v[176:179], 0
    v_pk_mul_f32 v[48:49], v[48:49], v[2:3]
    v_pk_mul_f32 v[50:51], v[50:51], v[2:3]
    v_pk_mul_f32 v[52:53], v[52:53], v[2:3]
    v_pk_mul_f32 v[54:55], v[54:55], v[2:3]
    v_cvt_pk_bf16_f32 v184, v48, v49
    v_cvt_pk_bf16_f32 v185, v50, v51
    v_cvt_pk_bf16_f32 v186, v52, v53
    v_cvt_pk_bf16_f32 v187, v54, v55
    v_permlane16_swap_b32 v180, v182
    v_permlane16_swap_b32 v181, v183
    buffer_store_dwordx4 v[180:183], v14, s[32:35], s51 offen offset:1024 sc1
    s_nop 0
    v_mfma_f32_32x32x16_bf16 v[80:95], v[20:23], v[180:183], 0
    v_pk_mul_f32 v[56:57], v[56:57], v[2:3]
    v_pk_mul_f32 v[58:59], v[58:59], v[2:3]
    v_pk_mul_f32 v[60:61], v[60:61], v[2:3]
    v_pk_mul_f32 v[62:63], v[62:63], v[2:3]
    v_cvt_pk_bf16_f32 v188, v56, v57
    v_cvt_pk_bf16_f32 v189, v58, v59
    v_cvt_pk_bf16_f32 v190, v60, v61
    v_cvt_pk_bf16_f32 v191, v62, v63
    v_permlane16_swap_b32 v184, v186
    v_permlane16_swap_b32 v185, v187
    buffer_store_dwordx4 v[184:187], v14, s[32:35], s51 offen offset:2048 sc1
    s_nop 0
    v_mfma_f32_32x32x16_bf16 v[104:119], v[24:27], v[184:187], 0
    v_permlane16_swap_b32 v188, v190
    v_permlane16_swap_b32 v189, v191
    buffer_store_dwordx4 v[188:191], v14, s[32:35], s51 offen offset:3072 sc1
    s_nop 0
    v_mfma_f32_32x32x16_bf16 v[120:135], v[28:31], v[188:191], 0
    v_max3_f32 v96, v64, v65, v66
    v_max3_f32 v64, v67, v68, v69
    v_max3_f32 v96, v96, v70, v71
    v_max3_f32 v64, v64, v72, v73
    v_max3_f32 v96, v96, v74, v75
    v_max3_f32 v64, v64, v76, v77
    v_max3_f32 v96, v96, v78, v79
    v_max_f32 v96, v96, v64
    v_max3_f32 v97, v80, v81, v82
    v_max3_f32 v80, v83, v84, v85
    v_max3_f32 v97, v97, v86, v87
    v_max3_f32 v80, v80, v88, v89
    v_max3_f32 v97, v97, v90, v91
    v_max3_f32 v80, v80, v92, v93
    v_max3_f32 v97, v97, v94, v95
    v_max_f32 v97, v97, v80
    v_max3_f32 v98, v104, v105, v106
    v_max3_f32 v104, v107, v108, v109
    v_max3_f32 v98, v98, v110, v111
    v_max3_f32 v104, v104, v112, v113
    v_max3_f32 v98, v98, v114, v115
    v_max3_f32 v104, v104, v116, v117
    v_max3_f32 v98, v98, v118, v119
    v_max_f32 v98, v98, v104
    v_max3_f32 v99, v120, v121, v122
    v_max3_f32 v120, v123, v124, v125
    v_max3_f32 v99, v99, v126, v127
    v_max3_f32 v120, v120, v128, v129
    v_max3_f32 v99, v99, v130, v131
    v_max3_f32 v120, v120, v132, v133
    v_max3_f32 v99, v99, v134, v135
    v_max_f32 v99, v99, v120
    v_mov_b32 v64, v96
    v_mov_b32 v65, v97
    v_mov_b32 v66, v98
    v_mov_b32 v67, v99
    v_permlane32_swap_b32 v96, v64
    v_permlane32_swap_b32 v97, v65
    v_permlane32_swap_b32 v98, v66
    v_permlane32_swap_b32 v99, v67
    v_max_f32 v96, v96, v64
    v_max_f32 v97, v97, v65
    v_max_f32 v98, v98, v66
    v_max_f32 v99, v99, v67
    v_cvt_pk_bf16_f32 v96, -v96, 0
    v_cvt_pk_bf16_f32 v97, -v97, 0
    v_cvt_pk_bf16_f32 v98, -v98, 0
    v_cvt_pk_bf16_f32 v99, -v99, 0
    s_mov_b32 exec_hi, 0
    buffer_store_dwordx4 v[96:99], v14, s[32:35], s55 offen sc1
    s_mov_b32 exec_hi, -1
    s_setprio 2
    v_mov_b32 v104, v237
    v_mov_b32 v105, 0
    v_mov_b32 v124, 0x3f803f80
    v_mov_b32 v125, 0
    v_mfma_f32_32x32x8_bf16 v[128:143], v[104:105], v[96:97], 0
    v_mov_b32 v126, v6
    v_mov_b32 v127, 0
    v_mov_b32 v13, v232
    v_mov_b32 v8, v233
    v_mov_b32 v9, v234
    v_mov_b32 v10, v235
    v_mov_b32 v11, v236
    v_mov_b32 v12, v237
    v_mfma_f32_32x32x8_bf16 v[224:239], v[124:125], v[126:127], 0
    v_mov_b32 v108, 0
    v_mov_b32 v109, 0
    v_mov_b32 v106, 0
    v_mov_b32 v107, v12
    v_mfma_f32_32x32x16_bf16 v[32:47], v[16:19], v[176:179], v[128:143]
    v_mov_b32 v110, 0xdddd
    v_lshlrev_b32 v100, 2, v0
    s_waitcnt lgkmcnt(0)
    s_mul_i32 s49, s49, 0x9e3779b1
    s_add_u32 s49, s49, 0x7f4a7c15
    v_mov_b32 v101, s49
    v_mfma_f32_32x32x8_bf16 v[64:79], v[108:109], v[108:109], 0
    v_permlane16_swap_b32 v240, v224
    v_permlane16_swap_b32 v241, v225
    v_permlane16_swap_b32 v242, v226
    v_permlane16_swap_b32 v243, v227
    v_permlane16_swap_b32 v244, v228
    v_permlane16_swap_b32 v245, v229
    v_exp_f32 v32, v32
    v_permlane16_swap_b32 v246, v230
    v_exp_f32 v33, v33
    v_exp_f32 v34, v34
    v_permlane16_swap_b32 v247, v231
    v_exp_f32 v35, v35
    v_exp_f32 v36, v36
    v_mfma_f32_32x32x16_bf16 v[48:63], v[20:23], v[176:179], v[128:143]
    v_exp_f32 v37, v37
    v_exp_f32 v38, v38
    v_exp_f32 v39, v39
    v_exp_f32 v40, v40
    v_exp_f32 v41, v41
    v_exp_f32 v42, v42
    v_smfmac_f32_32x32x32_bf16 v[64:79], v[240:243], v[32:39], v110
    v_exp_f32 v43, v43
    v_exp_f32 v44, v44
    v_exp_f32 v45, v45
    v_mfma_f32_32x32x8_bf16 v[80:95], v[108:109], v[108:109], 0
    v_exp_f32 v46, v46
    v_exp_f32 v47, v47
    v_exp_f32 v48, v48
    v_exp_f32 v49, v49
    v_smfmac_f32_32x32x32_bf16 v[64:79], v[224:227], v[40:47], v110
    v_exp_f32 v50, v50
    v_exp_f32 v51, v51
    v_exp_f32 v52, v52
    v_permlane16_swap_b32 v248, v232
    v_mfma_f32_32x32x16_bf16 v[32:47], v[24:27], v[176:179], v[128:143]
    v_exp_f32 v53, v53
    v_exp_f32 v54, v54
    v_permlane16_swap_b32 v249, v233
    v_exp_f32 v55, v55
    v_exp_f32 v56, v56
    v_permlane16_swap_b32 v250, v234
    v_exp_f32 v57, v57
    v_exp_f32 v58, v58
    v_permlane16_swap_b32 v251, v235
    v_smfmac_f32_32x32x32_bf16 v[64:79], v[244:247], v[48:55], v110
    v_exp_f32 v59, v59
    v_exp_f32 v60, v60
    v_permlane16_swap_b32 v252, v236
    v_exp_f32 v61, v61
    v_mfma_f32_32x32x8_bf16 v[192:207], v[124:125], v[126:127], 0
    v_exp_f32 v62, v62
    v_permlane16_swap_b32 v253, v237
    v_exp_f32 v63, v63
    v_exp_f32 v32, v32
    v_permlane16_swap_b32 v254, v238
    v_exp_f32 v33, v33
    v_smfmac_f32_32x32x32_bf16 v[64:79], v[228:231], v[56:63], v110
    v_exp_f32 v34, v34
    v_permlane16_swap_b32 v255, v239
    v_exp_f32 v35, v35
    v_exp_f32 v36, v36
    v_mfma_f32_32x32x16_bf16 v[48:63], v[28:31], v[176:179], v[128:143]
    v_exp_f32 v37, v37
    v_exp_f32 v38, v38
    v_exp_f32 v39, v39
    v_mfma_f32_32x32x8_bf16 v[128:143], v[106:107], v[96:97], 0
    v_exp_f32 v40, v40
    v_exp_f32 v41, v41
    v_exp_f32 v42, v42
    v_smfmac_f32_32x32x32_bf16 v[64:79], v[248:251], v[32:39], v110
    v_exp_f32 v43, v43
    v_exp_f32 v44, v44
    v_exp_f32 v45, v45
    v_exp_f32 v46, v46
    v_exp_f32 v47, v47
    v_exp_f32 v48, v48
    v_exp_f32 v49, v49
    v_smfmac_f32_32x32x32_bf16 v[64:79], v[232:235], v[40:47], v110
    v_exp_f32 v50, v50
    v_exp_f32 v51, v51
    v_exp_f32 v52, v52
    v_mfma_f32_32x32x16_bf16 v[32:47], v[16:19], v[180:183], v[128:143]
    v_exp_f32 v53, v53
    v_exp_f32 v54, v54
    v_exp_f32 v55, v55
    v_exp_f32 v56, v56
    v_exp_f32 v57, v57
    v_exp_f32 v58, v58
    v_smfmac_f32_32x32x32_bf16 v[64:79], v[252:255], v[48:55], v110
    v_exp_f32 v59, v59
    v_exp_f32 v60, v60
    v_exp_f32 v61, v61
    v_mfma_f32_32x32x8_bf16 v[208:223], v[124:125], v[126:127], 0
    v_exp_f32 v62, v62
    v_exp_f32 v63, v63
    v_exp_f32 v32, v32
    v_exp_f32 v33, v33
    v_smfmac_f32_32x32x32_bf16 v[64:79], v[236:239], v[56:63], v110
    v_exp_f32 v34, v34
    v_exp_f32 v35, v35
    v_exp_f32 v36, v36
    v_mfma_f32_32x32x16_bf16 v[48:63], v[20:23], v[180:183], v[128:143]
    v_exp_f32 v37, v37
    v_exp_f32 v38, v38
    v_exp_f32 v39, v39
    v_exp_f32 v40, v40
    s_waitcnt vmcnt(0)
    s_mov_b32 exec_hi, 0
    buffer_store_dword v101, v100, s[32:35], s54 offen sc1
    s_mov_b32 exec_hi, -1
    v_exp_f32 v41, v41
    v_exp_f32 v42, v42
    v_smfmac_f32_32x32x32_bf16 v[80:95], v[240:243], v[32:39], v110
    v_exp_f32 v43, v43
    v_exp_f32 v44, v44
    v_exp_f32 v45, v45
    v_exp_f32 v46, v46
    v_exp_f32 v47, v47
    v_exp_f32 v48, v48
    v_cvt_pk_bf16_f32 v144, v64, v65
    v_exp_f32 v49, v49
    v_smfmac_f32_32x32x32_bf16 v[80:95], v[224:227], v[40:47], v110
    v_exp_f32 v50, v50
    v_cvt_pk_bf16_f32 v145, v66, v67
    v_exp_f32 v51, v51
    v_exp_f32 v52, v52
    v_mfma_f32_32x32x16_bf16 v[32:47], v[24:27], v[180:183], v[128:143]
    v_cvt_pk_bf16_f32 v146, v68, v69
    v_exp_f32 v53, v53
    v_exp_f32 v54, v54
    v_cvt_pk_bf16_f32 v147, v70, v71
    v_exp_f32 v55, v55
    v_exp_f32 v56, v56
    v_mov_b32 v102, v72
    v_exp_f32 v57, v57
    v_exp_f32 v58, v58
    v_smfmac_f32_32x32x32_bf16 v[80:95], v[244:247], v[48:55], v110
    v_exp_f32 v59, v59
    v_exp_f32 v60, v60
    v_exp_f32 v61, v61
    v_exp_f32 v62, v62
    v_exp_f32 v63, v63
    v_exp_f32 v32, v32
    s_barrier
    v_exp_f32 v33, v33
    v_smfmac_f32_32x32x32_bf16 v[80:95], v[228:231], v[56:63], v110
    v_exp_f32 v34, v34
    v_exp_f32 v35, v35
    v_exp_f32 v36, v36
    v_mfma_f32_32x32x16_bf16 v[48:63], v[28:31], v[180:183], v[128:143]
    v_exp_f32 v37, v37
    v_exp_f32 v38, v38
    v_exp_f32 v39, v39
    v_mfma_f32_32x32x8_bf16 v[128:143], v[104:105], v[98:99], 0
    v_exp_f32 v40, v40
    v_exp_f32 v41, v41
    v_exp_f32 v42, v42
    v_smfmac_f32_32x32x32_bf16 v[80:95], v[248:251], v[32:39], v110
    v_exp_f32 v43, v43
    v_exp_f32 v44, v44
    v_exp_f32 v45, v45
    v_mfma_f32_32x32x8_bf16 v[64:79], v[108:109], v[108:109], 0
    v_exp_f32 v46, v46
    v_exp_f32 v47, v47
    v_exp_f32 v48, v48
    v_exp_f32 v49, v49
    v_smfmac_f32_32x32x32_bf16 v[80:95], v[232:235], v[40:47], v110
    v_exp_f32 v50, v50
    v_exp_f32 v51, v51
    v_exp_f32 v52, v52
    v_mfma_f32_32x32x16_bf16 v[32:47], v[16:19], v[184:187], v[128:143]
    v_exp_f32 v53, v53
    v_exp_f32 v54, v54
    v_exp_f32 v55, v55
    v_exp_f32 v56, v56
    v_exp_f32 v57, v57
    v_exp_f32 v58, v58
    v_smfmac_f32_32x32x32_bf16 v[80:95], v[252:255], v[48:55], v110
    v_exp_f32 v59, v59
    v_exp_f32 v60, v60
    v_exp_f32 v61, v61
    v_exp_f32 v62, v62
    v_exp_f32 v63, v63
    v_exp_f32 v32, v32
    v_exp_f32 v33, v33
    v_smfmac_f32_32x32x32_bf16 v[80:95], v[236:239], v[56:63], v110
    v_exp_f32 v34, v34
    v_exp_f32 v35, v35
    v_exp_f32 v36, v36
    v_mfma_f32_32x32x16_bf16 v[48:63], v[20:23], v[184:187], v[128:143]
    v_exp_f32 v37, v37
    v_exp_f32 v38, v38
    v_exp_f32 v39, v39
    v_exp_f32 v40, v40
    v_exp_f32 v41, v41
    v_exp_f32 v42, v42
    v_smfmac_f32_32x32x32_bf16 v[64:79], v[240:243], v[32:39], v110
    v_exp_f32 v43, v43
    v_exp_f32 v44, v44
    v_exp_f32 v45, v45
    v_exp_f32 v46, v46
    v_exp_f32 v47, v47
    v_exp_f32 v48, v48
    v_cvt_pk_bf16_f32 v148, v80, v81
    v_exp_f32 v49, v49
    v_smfmac_f32_32x32x32_bf16 v[64:79], v[224:227], v[40:47], v110
    v_exp_f32 v50, v50
    v_cvt_pk_bf16_f32 v149, v82, v83
    v_exp_f32 v51, v51
    v_exp_f32 v52, v52
    v_mfma_f32_32x32x16_bf16 v[32:47], v[24:27], v[184:187], v[128:143]
    v_cvt_pk_bf16_f32 v150, v84, v85
    v_exp_f32 v53, v53
    v_exp_f32 v54, v54
    v_cvt_pk_bf16_f32 v151, v86, v87
    v_exp_f32 v55, v55
    v_exp_f32 v56, v56
    v_cndmask_b32 v102, v88, v102, s[56:57]
    v_exp_f32 v57, v57
    v_exp_f32 v58, v58
    v_smfmac_f32_32x32x32_bf16 v[64:79], v[244:247], v[48:55], v110
    v_exp_f32 v59, v59
    v_exp_f32 v60, v60
    v_exp_f32 v61, v61
    v_exp_f32 v62, v62
    v_exp_f32 v63, v63
    v_exp_f32 v32, v32
    v_exp_f32 v33, v33
    v_smfmac_f32_32x32x32_bf16 v[64:79], v[228:231], v[56:63], v110
    v_exp_f32 v34, v34
    v_exp_f32 v35, v35
    v_exp_f32 v36, v36
    v_mfma_f32_32x32x16_bf16 v[48:63], v[28:31], v[184:187], v[128:143]
    v_exp_f32 v37, v37
    v_exp_f32 v38, v38
    v_exp_f32 v39, v39
    v_mfma_f32_32x32x8_bf16 v[128:143], v[106:107], v[98:99], 0
    v_exp_f32 v40, v40
    v_exp_f32 v41, v41
    v_exp_f32 v42, v42
    v_smfmac_f32_32x32x32_bf16 v[64:79], v[248:251], v[32:39], v110
    v_exp_f32 v43, v43
    v_exp_f32 v44, v44
    v_exp_f32 v45, v45
    v_mfma_f32_32x32x8_bf16 v[80:95], v[108:109], v[108:109], 0
    v_exp_f32 v46, v46
    v_exp_f32 v47, v47
    v_exp_f32 v48, v48
    v_exp_f32 v49, v49
    v_smfmac_f32_32x32x32_bf16 v[64:79], v[232:235], v[40:47], v110
    v_exp_f32 v50, v50
    v_exp_f32 v51, v51
    v_exp_f32 v52, v52
    v_mfma_f32_32x32x16_bf16 v[32:47], v[16:19], v[188:191], v[128:143]
    v_exp_f32 v53, v53
    v_exp_f32 v54, v54
    v_exp_f32 v55, v55
    v_exp_f32 v56, v56
    v_exp_f32 v57, v57
    v_exp_f32 v58, v58
    v_smfmac_f32_32x32x32_bf16 v[64:79], v[252:255], v[48:55], v110
    v_exp_f32 v59, v59
    v_exp_f32 v60, v60
    v_exp_f32 v61, v61
    v_exp_f32 v62, v62
    v_exp_f32 v63, v63
    v_exp_f32 v32, v32
    v_exp_f32 v33, v33
    v_smfmac_f32_32x32x32_bf16 v[64:79], v[236:239], v[56:63], v110
    v_exp_f32 v34, v34
    v_exp_f32 v35, v35
    v_exp_f32 v36, v36
    v_mfma_f32_32x32x16_bf16 v[48:63], v[20:23], v[188:191], v[128:143]
    v_exp_f32 v37, v37
    v_exp_f32 v38, v38
    v_exp_f32 v39, v39
    v_exp_f32 v40, v40
    v_exp_f32 v41, v41
    v_exp_f32 v42, v42
    v_smfmac_f32_32x32x32_bf16 v[80:95], v[240:243], v[32:39], v110
    v_exp_f32 v43, v43
    v_exp_f32 v44, v44
    v_exp_f32 v45, v45
    v_exp_f32 v46, v46
    v_exp_f32 v47, v47
    v_exp_f32 v48, v48
    v_cvt_pk_bf16_f32 v152, v64, v65
    v_exp_f32 v49, v49
    v_smfmac_f32_32x32x32_bf16 v[80:95], v[224:227], v[40:47], v110
    v_exp_f32 v50, v50
    v_cvt_pk_bf16_f32 v153, v66, v67
    v_exp_f32 v51, v51
    v_exp_f32 v52, v52
    v_mfma_f32_32x32x16_bf16 v[32:47], v[24:27], v[188:191], v[128:143]
    v_cvt_pk_bf16_f32 v154, v68, v69
    v_exp_f32 v53, v53
    v_exp_f32 v54, v54
    v_cvt_pk_bf16_f32 v155, v70, v71
    v_exp_f32 v55, v55
    v_exp_f32 v56, v56
    v_mov_b32 v103, v72
    v_exp_f32 v57, v57
    v_exp_f32 v58, v58
    v_smfmac_f32_32x32x32_bf16 v[80:95], v[244:247], v[48:55], v110
    v_exp_f32 v59, v59
    v_exp_f32 v60, v60
    buffer_load_dword v2, v1, s[32:35], s80 offen sc1
    v_exp_f32 v61, v61
    v_exp_f32 v62, v62
    v_exp_f32 v63, v63
    v_exp_f32 v32, v32
    v_exp_f32 v33, v33
    v_smfmac_f32_32x32x32_bf16 v[80:95], v[228:231], v[56:63], v110
    v_exp_f32 v34, v34
    v_exp_f32 v35, v35
    v_exp_f32 v36, v36
    v_mfma_f32_32x32x16_bf16 v[48:63], v[28:31], v[188:191], v[128:143]
    v_exp_f32 v37, v37
    v_exp_f32 v38, v38
    v_exp_f32 v39, v39
    v_exp_f32 v40, v40
    v_exp_f32 v41, v41
    v_exp_f32 v42, v42
    v_smfmac_f32_32x32x32_bf16 v[80:95], v[248:251], v[32:39], v110
    v_exp_f32 v43, v43
    v_exp_f32 v44, v44
    v_exp_f32 v45, v45
    v_exp_f32 v46, v46
    v_exp_f32 v47, v47
    v_exp_f32 v48, v48
    v_exp_f32 v49, v49
    v_smfmac_f32_32x32x32_bf16 v[80:95], v[232:235], v[40:47], v110
    v_exp_f32 v50, v50
    v_exp_f32 v51, v51
    v_exp_f32 v52, v52
    v_exp_f32 v53, v53
    v_exp_f32 v54, v54
    v_exp_f32 v55, v55
    v_exp_f32 v56, v56
    v_exp_f32 v57, v57
    v_exp_f32 v58, v58
    v_smfmac_f32_32x32x32_bf16 v[80:95], v[252:255], v[48:55], v110
    v_exp_f32 v59, v59
    v_exp_f32 v60, v60
    v_exp_f32 v61, v61
    v_exp_f32 v62, v62
    v_exp_f32 v63, v63
    v_mov_b32 v28, v102
    s_setprio 3
    v_smfmac_f32_32x32x32_bf16 v[80:95], v[236:239], v[56:63], v110
    s_nop 11
    v_cvt_pk_bf16_f32 v156, v80, v81
    v_cvt_pk_bf16_f32 v157, v82, v83
    v_cvt_pk_bf16_f32 v158, v84, v85
    v_cvt_pk_bf16_f32 v159, v86, v87
    v_cndmask_b32 v103, v88, v103, s[56:57]
    v_mov_b32 v29, v103
    s_waitcnt vmcnt(0)
    v_cmp_ne_u32 vcc, s49, v2
    s_nop 1
    s_cbranch_vccz L_kvp_x
L_poll2:
    s_mov_b32 s70, 0
L_kvp:
    buffer_load_dword v2, v1, s[32:35], s80 offen sc1
    s_add_u32 s70, s70, 1
    s_cmp_gt_u32 s70, 65536
    s_waitcnt vmcnt(0)
    v_cmp_ne_u32 vcc, s49, v2
    s_cbranch_scc1 L_kvp_x
    s_nop 0
    s_cbranch_vccnz L_kvp
L_kvp_x:
    buffer_load_dword v120, v5, s[32:35], s83 offen sc1
    buffer_load_dword v122, v5, s[32:35], s82 offen sc1
    buffer_load_dwordx4 v[116:119], v14, s[32:35], s84 offen sc1
    buffer_load_dwordx4 v[160:163], v14, s[32:35], s72 offen sc1
    buffer_load_dwordx4 v[112:115], v14, s[32:35], s81 offen sc1
    s_mov_b64 exec, s[100:101]
    buffer_load_dwordx4 v[192:195], v15, s[32:35], s72 offen offset:0 sc1
    buffer_load_dwordx4 v[196:199], v15, s[32:35], s72 offen offset:256 sc1
    s_mov_b64 exec, -1
    buffer_load_dwordx4 v[164:167], v14, s[32:35], s73 offen sc1
    s_mov_b64 exec, s[100:101]
    buffer_load_dwordx4 v[200:203], v15, s[32:35], s73 offen offset:0 sc1
    buffer_load_dwordx4 v[204:207], v15, s[32:35], s73 offen offset:256 sc1
    s_mov_b64 exec, -1
    buffer_load_dwordx4 v[168:171], v14, s[32:35], s74 offen sc1
    s_mov_b64 exec, s[100:101]
    buffer_load_dwordx4 v[208:211], v15, s[32:35], s74 offen offset:0 sc1
    buffer_load_dwordx4 v[212:215], v15, s[32:35], s74 offen offset:256 sc1
    s_mov_b64 exec, -1
    s_branch L_qkv_done
L_cons_b:
    s_xor_b32 s42, s42, 0
    v_and_b32 v1, 15, v0
    v_lshrrev_b32 v2, 4, v0
    v_lshlrev_b32 v2, 2, v2
    v_sub_u32 v1, v1, v2
    v_mov_b32 v3, 0xf149f2ca
    s_cmp_eq_u32 s41, 0
    s_cselect_b64 s[52:53], -1, 0
    v_subrev_u32 v4, 0, v1
    v_and_b32 v5, -15, v4
    v_cmp_eq_u32 vcc, 0, v5
    v_add_u32 v4, 16, v4
    v_and_b32 v5, -15, v4
    v_cndmask_b32 v16, v3, 0, vcc
    v_cmp_eq_u32 vcc, 0, v5
    v_mov_b32 v28, 0x3f803f80
    s_nop 0
    v_cndmask_b32 v20, v3, 0, vcc
    v_cndmask_b32 v24, v20, v3, s[52:53]
    v_subrev_u32 v4, 1, v1
    v_and_b32 v5, -15, v4
    v_cmp_eq_u32 vcc, 0, v5
    v_add_u32 v4, 16, v4
    v_and_b32 v5, -15, v4
    v_cndmask_b32 v17, v3, 0, vcc
    v_cmp_eq_u32 vcc, 0, v5
    v_mov_b32 v29, 0x3f803f80
    s_nop 0
    v_cndmask_b32 v21, v3, 0, vcc
    v_cndmask_b32 v25, v21, v3, s[52:53]
    v_subrev_u32 v4, 2, v1
    v_and_b32 v5, -15, v4
    v_cmp_eq_u32 vcc, 0, v5
    v_add_u32 v4, 16, v4
    v_and_b32 v5, -15, v4
    v_cndmask_b32 v18, v3, 0, vcc
    v_cmp_eq_u32 vcc, 0, v5
    v_mov_b32 v30, 0x3f803f80
    s_nop 0
    v_cndmask_b32 v22, v3, 0, vcc
    v_cndmask_b32 v26, v22, v3, s[52:53]
    v_subrev_u32 v4, 3, v1
    v_and_b32 v5, -15, v4
    v_cmp_eq_u32 vcc, 0, v5
    v_add_u32 v4, 16, v4
    v_and_b32 v5, -15, v4
    v_cndmask_b32 v19, v3, 0, vcc
    v_cmp_eq_u32 vcc, 0, v5
    v_mov_b32 v31, 0x3f803f80
    s_nop 0
    v_cndmask_b32 v23, v3, 0, vcc
    v_cndmask_b32 v27, v23, v3, s[52:53]
    v_and_b32 v1, 1, v0
    v_cmp_eq_u32 vcc, 0, v1
    v_mov_b32 v1, 0x03020c0c
    v_mov_b32 v6, 0x0c0c0302
    v_cndmask_b32 v6, v1, v6, vcc
    s_lshl2_add_u32 s50, s42, s22
    s_lshl_b32 s52, s50, 2
    s_lshl_b32 s50, s50, 10
    s_lshl_b32 s51, s41, 17
    s_add_u32 s50, s50, s51
    s_add_u32 s50, s50, 8388608
    s_lshl_b32 s53, s41, 7
    s_add_u32 s52, s52, s53
    s_add_u32 s23, s52, 10493952
    s_mov_b32 s63, 0
    v_and_b32 v1, 59, v0
    v_cmp_eq_u32 vcc, 16, v1
    v_mov_b32 v2, 0x3afe3f80
    v_mov_b32 v3, 0
    v_cndmask_b32 v2, 0, v2, vcc
    s_and_b32 s80, s45, 1
    s_lshl_b32 s80, s80, 2
    s_xor_b32 s80, s80, s40
    s_mul_i32 s80, s80, 7
    v_add_u32 v1, s80, v0
    s_lshl_b32 s80, s45, 3
    v_cmp_le_u32 vcc, s80, v1
    v_add_u32 v5, 8, v1
    s_nop 0
    v_cndmask_b32 v1, v1, v5, vcc
    s_lshl3_add_u32 s80, s45, s40
    v_mov_b32 v5, s80
    v_cmp_gt_u32 vcc, 7, v0
    s_lshl_b32 s80, s44, 11
    s_add_u32 s80, s80, 10616832
    v_cndmask_b32 v1, v5, v1, vcc
    v_bfe_u32 v1, v1, 2, 4
    v_lshlrev_b32 v1, 7, v1
    v_and_b32 v5, 0x1f0, v14
    s_xor_b32 s81, s84, 1024
    s_xor_b32 s82, s83, 4
    s_mov_b32 s59, 0
    s_waitcnt vmcnt(0)
    s_barrier
    ds_read_b64_tr_b16 v[176:177], v13 offset:19456
    ds_read_b64_tr_b16 v[178:179], v13 offset:19968
    ds_read_b128 v[136:139], v11 offset:0
    ds_read_b64_tr_b16 v[180:181], v13 offset:20480
    ds_read_b64_tr_b16 v[182:183], v13 offset:20992
    ds_read_b64_tr_b16 v[172:173], v13 offset:18432
    ds_read_b64_tr_b16 v[174:175], v13 offset:18944
    ds_read_b128 v[140:143], v11 offset:2048
    ds_read_b128 v[144:147], v11 offset:4096
    ds_read_b128 v[148:151], v11 offset:6144
    ds_read_b128 v[152:155], v11 offset:8192
    ds_read_b128 v[156:159], v11 offset:10240
    ds_read_b128 v[160:163], v11 offset:12288
    ds_read_b128 v[164:167], v11 offset:14336
    ds_read_b128 v[168:171], v11 offset:16384
    s_branch L_gm_B
L_g_B:
    s_barrier
    v_mfma_f32_16x16x32_bf16 v[64:67], v[224:227], v[184:187], v[64:67]
    ds_read_b64_tr_b16 v[176:177], v13 offset:19456
    v_mfma_f32_16x16x32_bf16 v[100:103], v[184:187], v[228:231], v[100:103]
    ds_read_b64_tr_b16 v[178:179], v13 offset:19968
    v_mfma_f32_16x16x32_bf16 v[68:71], v[224:227], v[188:191], v[68:71]
    ds_read_b128 v[136:139], v11 offset:0
    v_mfma_f32_16x16x32_bf16 v[104:107], v[188:191], v[228:231], v[104:107]
    ds_read_b64_tr_b16 v[180:181], v13 offset:20480
    v_mfma_f32_16x16x32_bf16 v[32:35], v[220:223], v[188:191], v[32:35]
    ds_read_b64_tr_b16 v[182:183], v13 offset:20992
    v_mfma_f32_16x16x32_bf16 v[72:75], v[224:227], v[192:195], v[72:75]
    ds_read_b64_tr_b16 v[172:173], v13 offset:18432
    v_mfma_f32_16x16x32_bf16 v[108:111], v[192:195], v[228:231], v[108:111]
    ds_read_b64_tr_b16 v[174:175], v13 offset:18944
    v_mfma_f32_16x16x32_bf16 v[36:39], v[220:223], v[192:195], v[36:39]
    ds_read_b128 v[140:143], v11 offset:2048
    v_mfma_f32_16x16x32_bf16 v[76:79], v[224:227], v[196:199], v[76:79]
    ds_read_b128 v[144:147], v11 offset:4096
    v_mfma_f32_16x16x32_bf16 v[112:115], v[196:199], v[228:231], v[112:115]
    ds_read_b128 v[148:151], v11 offset:6144
    v_mfma_f32_16x16x32_bf16 v[40:43], v[220:223], v[196:199], v[40:43]
    ds_read_b128 v[152:155], v11 offset:8192
    v_mfma_f32_16x16x32_bf16 v[80:83], v[224:227], v[200:203], v[80:83]
    ds_read_b128 v[156:159], v11 offset:10240
    v_mfma_f32_16x16x32_bf16 v[116:119], v[200:203], v[228:231], v[116:119]
    ds_read_b128 v[160:163], v11 offset:12288
    v_mfma_f32_16x16x32_bf16 v[44:47], v[220:223], v[200:203], v[44:47]
    ds_read_b128 v[164:167], v11 offset:14336
    v_mfma_f32_16x16x32_bf16 v[84:87], v[224:227], v[204:207], v[84:87]
    ds_read_b128 v[168:171], v11 offset:16384
    v_mfma_f32_16x16x32_bf16 v[120:123], v[204:207], v[228:231], v[120:123]
    v_mfma_f32_16x16x32_bf16 v[48:51], v[220:223], v[204:207], v[48:51]
    v_mfma_f32_16x16x32_bf16 v[88:91], v[224:227], v[208:211], v[88:91]
    v_mfma_f32_16x16x32_bf16 v[124:127], v[208:211], v[228:231], v[124:127]
    v_mfma_f32_16x16x32_bf16 v[52:55], v[220:223], v[208:211], v[52:55]
    v_mfma_f32_16x16x32_bf16 v[92:95], v[224:227], v[212:215], v[92:95]
    v_mfma_f32_16x16x32_bf16 v[128:131], v[212:215], v[228:231], v[128:131]
    v_mfma_f32_16x16x32_bf16 v[56:59], v[220:223], v[212:215], v[56:59]
    v_mfma_f32_16x16x32_bf16 v[96:99], v[224:227], v[216:219], v[96:99]
    v_mfma_f32_16x16x32_bf16 v[132:135], v[216:219], v[228:231], v[132:135]
    v_mfma_f32_16x16x32_bf16 v[60:63], v[220:223], v[216:219], v[60:63]
L_gm_B:
    s_waitcnt lgkmcnt(0)
    v_mfma_f32_16x16x32_bf16 v[64:67], v[176:179], v[136:139], v[64:67]
    ds_read_b64_tr_b16 v[224:225], v13 offset:31744
    v_mfma_f32_16x16x32_bf16 v[100:103], v[136:139], v[180:183], v[100:103]
    ds_read_b64_tr_b16 v[226:227], v13 offset:32256
    v_mfma_f32_16x16x32_bf16 v[68:71], v[176:179], v[140:143], v[68:71]
    ds_read_b128 v[184:187], v12 offset:0
    v_mfma_f32_16x16x32_bf16 v[104:107], v[140:143], v[180:183], v[104:107]
    ds_read_b64_tr_b16 v[228:229], v13 offset:32768
    v_mfma_f32_16x16x32_bf16 v[32:35], v[172:175], v[140:143], v[32:35]
    ds_read_b64_tr_b16 v[230:231], v13 offset:33280
    v_mfma_f32_16x16x32_bf16 v[72:75], v[176:179], v[144:147], v[72:75]
    ds_read_b64_tr_b16 v[220:221], v13 offset:30720
    v_mfma_f32_16x16x32_bf16 v[108:111], v[144:147], v[180:183], v[108:111]
    ds_read_b64_tr_b16 v[222:223], v13 offset:31232
    v_mfma_f32_16x16x32_bf16 v[36:39], v[172:175], v[144:147], v[36:39]
    ds_read_b128 v[188:191], v12 offset:2048
    v_mfma_f32_16x16x32_bf16 v[76:79], v[176:179], v[148:151], v[76:79]
    ds_read_b128 v[192:195], v12 offset:4096
    v_mfma_f32_16x16x32_bf16 v[112:115], v[148:151], v[180:183], v[112:115]
    ds_read_b128 v[196:199], v12 offset:6144
    v_mfma_f32_16x16x32_bf16 v[40:43], v[172:175], v[148:151], v[40:43]
    ds_read_b128 v[200:203], v12 offset:8192
    v_mfma_f32_16x16x32_bf16 v[80:83], v[176:179], v[152:155], v[80:83]
    ds_read_b128 v[204:207], v12 offset:10240
    v_mfma_f32_16x16x32_bf16 v[116:119], v[152:155], v[180:183], v[116:119]
    ds_read_b128 v[208:211], v12 offset:12288
    v_mfma_f32_16x16x32_bf16 v[44:47], v[172:175], v[152:155], v[44:47]
    ds_read_b128 v[212:215], v12 offset:14336
    v_mfma_f32_16x16x32_bf16 v[84:87], v[176:179], v[156:159], v[84:87]
    ds_read_b128 v[216:219], v12 offset:16384
    v_mfma_f32_16x16x32_bf16 v[120:123], v[156:159], v[180:183], v[120:123]
    v_add_u32 v11, s60, v8
    v_mfma_f32_16x16x32_bf16 v[48:51], v[172:175], v[156:159], v[48:51]
    v_add_u32 v12, s60, v9
    v_mfma_f32_16x16x32_bf16 v[88:91], v[176:179], v[160:163], v[88:91]
    v_add_u32 v13, s60, v10
    v_mfma_f32_16x16x32_bf16 v[124:127], v[160:163], v[180:183], v[124:127]
    s_add_u32 s60, s60, 43008
    v_mfma_f32_16x16x32_bf16 v[52:55], v[172:175], v[160:163], v[52:55]
    s_cmp_eq_u32 s60, 129024
    v_mfma_f32_16x16x32_bf16 v[92:95], v[176:179], v[164:167], v[92:95]
    s_cselect_b32 s60, 0, s60
    v_mfma_f32_16x16x32_bf16 v[128:131], v[164:167], v[180:183], v[128:131]
    s_add_u32 s59, s59, 1
    v_mfma_f32_16x16x32_bf16 v[56:59], v[172:175], v[164:167], v[56:59]
    s_cmp_lt_u32 s59, 8
    v_mfma_f32_16x16x32_bf16 v[96:99], v[176:179], v[168:171], v[96:99]
    v_mfma_f32_16x16x32_bf16 v[132:135], v[168:171], v[180:183], v[132:135]
    v_mfma_f32_16x16x32_bf16 v[60:63], v[172:175], v[168:171], v[60:63]
    s_waitcnt lgkmcnt(0)
    s_cbranch_scc1 L_g_B
    s_load_dword s49, s[68:69], 0
    s_setprio 2
    v_mfma_f32_16x16x32_bf16 v[32:35], v[220:223], v[188:191], v[32:35]
    v_mfma_f32_16x16x32_bf16 v[36:39], v[220:223], v[192:195], v[36:39]
    v_mfma_f32_16x16x32_bf16 v[40:43], v[220:223], v[196:199], v[40:43]
    v_mfma_f32_16x16x32_bf16 v[44:47], v[220:223], v[200:203], v[44:47]
    v_mfma_f32_16x16x32_bf16 v[48:51], v[220:223], v[204:207], v[48:51]
    v_mfma_f32_16x16x32_bf16 v[52:55], v[220:223], v[208:211], v[52:55]
    v_mfma_f32_16x16x32_bf16 v[56:59], v[220:223], v[212:215], v[56:59]
    v_mfma_f32_16x16x32_bf16 v[60:63], v[220:223], v[216:219], v[60:63]
    v_mfma_f32_16x16x32_bf16 v[64:67], v[224:227], v[184:187], v[64:67]
    v_cvt_pk_bf16_f32 v32, v32, v33
    v_cvt_pk_bf16_f32 v33, v34, v35
    v_mfma_f32_16x16x32_bf16 v[68:71], v[224:227], v[188:191], v[68:71]
    v_cvt_pk_bf16_f32 v34, v36, v37
    v_cvt_pk_bf16_f32 v35, v38, v39
    v_mfma_f32_16x16x32_bf16 v[72:75], v[224:227], v[192:195], v[72:75]
    v_cvt_pk_bf16_f32 v36, v40, v41
    v_cvt_pk_bf16_f32 v37, v42, v43
    v_mfma_f32_16x16x32_bf16 v[76:79], v[224:227], v[196:199], v[76:79]
    v_cvt_pk_bf16_f32 v38, v44, v45
    v_cvt_pk_bf16_f32 v39, v46, v47
    v_mfma_f32_16x16x32_bf16 v[80:83], v[224:227], v[200:203], v[80:83]
    v_cvt_pk_bf16_f32 v40, v48, v49
    v_cvt_pk_bf16_f32 v41, v50, v51
    v_mfma_f32_16x16x32_bf16 v[84:87], v[224:227], v[204:207], v[84:87]
    v_cvt_pk_bf16_f32 v42, v52, v53
    v_cvt_pk_bf16_f32 v43, v54, v55
    v_mfma_f32_16x16x32_bf16 v[88:91], v[224:227], v[208:211], v[88:91]
    v_cvt_pk_bf16_f32 v44, v56, v57
    v_cvt_pk_bf16_f32 v45, v58, v59
    v_mfma_f32_16x16x32_bf16 v[92:95], v[224:227], v[212:215], v[92:95]
    v_cvt_pk_bf16_f32 v46, v60, v61
    v_cvt_pk_bf16_f32 v47, v62, v63
    v_mfma_f32_16x16x32_bf16 v[96:99], v[224:227], v[216:219], v[96:99]
    v_mfma_f32_16x16x32_bf16 v[100:103], v[184:187], v[228:231], v[100:103]
    v_cvt_pk_bf16_f32 v48, v64, v65
    v_cvt_pk_bf16_f32 v49, v66, v67
    v_mfma_f32_16x16x32_bf16 v[104:107], v[188:191], v[228:231], v[104:107]
    v_cvt_pk_bf16_f32 v50, v68, v69
    v_cvt_pk_bf16_f32 v51, v70, v71
    v_mfma_f32_16x16x32_bf16 v[108:111], v[192:195], v[228:231], v[108:111]
    v_cvt_pk_bf16_f32 v52, v72, v73
    v_cvt_pk_bf16_f32 v53, v74, v75
    v_mfma_f32_16x16x32_bf16 v[112:115], v[196:199], v[228:231], v[112:115]
    v_cvt_pk_bf16_f32 v54, v76, v77
    v_cvt_pk_bf16_f32 v55, v78, v79
    v_mfma_f32_16x16x32_bf16 v[116:119], v[200:203], v[228:231], v[116:119]
    v_cvt_pk_bf16_f32 v56, v80, v81
    v_cvt_pk_bf16_f32 v57, v82, v83
    v_mfma_f32_16x16x32_bf16 v[120:123], v[204:207], v[228:231], v[120:123]
    v_cvt_pk_bf16_f32 v58, v84, v85
    v_cvt_pk_bf16_f32 v59, v86, v87
    v_mfma_f32_16x16x32_bf16 v[124:127], v[208:211], v[228:231], v[124:127]
    v_cvt_pk_bf16_f32 v60, v88, v89
    v_cvt_pk_bf16_f32 v61, v90, v91
    v_mfma_f32_16x16x32_bf16 v[128:131], v[212:215], v[228:231], v[128:131]
    v_cvt_pk_bf16_f32 v62, v92, v93
    v_cvt_pk_bf16_f32 v63, v94, v95
    v_mfma_f32_16x16x32_bf16 v[132:135], v[216:219], v[228:231], v[132:135]
    v_cvt_pk_bf16_f32 v64, v96, v97
    v_cvt_pk_bf16_f32 v65, v98, v99
    v_mov_b32 v13, v232
    v_mov_b32 v8, v233
    v_mov_b32 v9, v234
    v_mov_b32 v10, v235
    v_mov_b32 v11, v236
    v_mov_b32 v12, v237
    v_mfma_f32_16x16x16_bf16 v[160:163], v[56:57], v[40:41], v[20:23]
    v_cvt_pk_bf16_f32 v66, v100, v101
    v_cvt_pk_bf16_f32 v67, v102, v103
    v_cvt_pk_bf16_f32 v68, v104, v105
    v_mfma_f32_16x16x16_bf16 v[164:167], v[58:59], v[40:41], v[16:19]
    v_cvt_pk_bf16_f32 v69, v106, v107
    v_cvt_pk_bf16_f32 v70, v108, v109
    v_cvt_pk_bf16_f32 v71, v110, v111
    v_mfma_f32_16x16x16_bf16 v[168:171], v[58:59], v[42:43], v[20:23]
    v_cvt_pk_bf16_f32 v72, v112, v113
    v_cvt_pk_bf16_f32 v73, v114, v115
    v_cvt_pk_bf16_f32 v74, v116, v117
    v_mfma_f32_16x16x16_bf16 v[172:175], v[60:61], v[42:43], v[16:19]
    v_cvt_pk_bf16_f32 v75, v118, v119
    v_cvt_pk_bf16_f32 v76, v120, v121
    v_cvt_pk_bf16_f32 v77, v122, v123
    v_mfma_f32_16x16x16_bf16 v[176:179], v[60:61], v[44:45], v[20:23]
    v_cvt_pk_bf16_f32 v78, v124, v125
    v_cvt_pk_bf16_f32 v79, v126, v127
    v_cvt_pk_bf16_f32 v80, v128, v129
    v_mfma_f32_16x16x16_bf16 v[180:183], v[62:63], v[44:45], v[16:19]
    v_cvt_pk_bf16_f32 v81, v130, v131
    v_cvt_pk_bf16_f32 v82, v132, v133
    v_cvt_pk_bf16_f32 v83, v134, v135
    v_mfma_f32_16x16x16_bf16 v[184:187], v[62:63], v[46:47], v[20:23]
    v_mfma_f32_16x16x16_bf16 v[188:191], v[64:65], v[46:47], v[16:19]
    v_mfma_f32_16x16x16_bf16 v[84:87], v[48:49], v[32:33], v[24:27]
    v_max_f32 v160, v160, v161
    v_max_f32 v161, v162, v163
    v_mfma_f32_16x16x16_bf16 v[88:91], v[50:51], v[32:33], v[16:19]
    v_max_f32 v162, v164, v165
    v_max_f32 v163, v166, v167
    v_mfma_f32_16x16x16_bf16 v[92:95], v[50:51], v[34:35], v[20:23]
    v_max_f32 v168, v168, v169
    v_max_f32 v169, v170, v171
    v_mfma_f32_16x16x16_bf16 v[96:99], v[52:53], v[34:35], v[16:19]
    v_max_f32 v170, v172, v173
    v_max_f32 v171, v174, v175
    v_mfma_f32_16x16x16_bf16 v[100:103], v[52:53], v[36:37], v[20:23]
    v_max_f32 v176, v176, v177
    v_max_f32 v177, v178, v179
    v_mfma_f32_16x16x16_bf16 v[104:107], v[54:55], v[36:37], v[16:19]
    v_max_f32 v178, v180, v181
    v_max_f32 v179, v182, v183
    v_mfma_f32_16x16x16_bf16 v[108:111], v[54:55], v[38:39], v[20:23]
    v_max_f32 v184, v184, v185
    v_max_f32 v185, v186, v187
    v_mfma_f32_16x16x16_bf16 v[112:115], v[56:57], v[38:39], v[16:19]
    v_max_f32 v186, v188, v189
    v_max_f32 v187, v190, v191
    v_max_f32 v84, v84, v85
    v_max_f32 v85, v86, v87
    v_max_f32 v86, v88, v89
    v_max_f32 v87, v90, v91
    v_mfma_f32_32x32x8_bf16 v[192:207], v[28:29], v[2:3], 0
    v_max_f32 v92, v92, v93
    v_max_f32 v93, v94, v95
    v_max_f32 v94, v96, v97
    v_max_f32 v95, v98, v99
    v_max_f32 v100, v100, v101
    v_max_f32 v101, v102, v103
    v_max_f32 v102, v104, v105
    v_max_f32 v103, v106, v107
    v_mfma_f32_32x32x8_bf16 v[208:223], v[28:29], v[2:3], 0
    v_max_f32 v108, v108, v109
    v_max_f32 v109, v110, v111
    v_max_f32 v110, v112, v113
    v_max_f32 v111, v114, v115
    v_max3_f32 v116, v160, v161, v162
    v_max3_f32 v124, v84, v85, v86
    v_max3_f32 v117, v168, v169, v170
    v_max3_f32 v125, v92, v93, v94
    v_mfma_f32_32x32x8_bf16 v[224:239], v[28:29], v[2:3], 0
    v_max3_f32 v118, v176, v177, v178
    v_max3_f32 v126, v100, v101, v102
    v_max3_f32 v119, v184, v185, v186
    v_max3_f32 v127, v108, v109, v110
    v_max_f32 v116, v116, v163
    v_max_f32 v124, v124, v87
    v_max_f32 v117, v117, v171
    v_max_f32 v125, v125, v95
    v_mfma_f32_32x32x8_bf16 v[240:255], v[28:29], v[2:3], 0
    v_max_f32 v118, v118, v179
    v_max_f32 v126, v126, v103
    v_max_f32 v119, v119, v187
    v_max_f32 v127, v127, v111
    v_permlane32_swap_b32 v116, v117
    v_permlane32_swap_b32 v124, v125
    v_permlane32_swap_b32 v118, v119
    v_permlane32_swap_b32 v126, v127
    v_max_f32 v116, v116, v117
    v_max_f32 v124, v124, v125
    v_max_f32 v118, v118, v119
    v_max_f32 v126, v126, v127
    s_nop 0
    v_permlane16_swap_b32 v116, v118
    v_permlane16_swap_b32 v124, v126
    v_max_f32 v116, v116, v118
    v_max_f32 v124, v124, v126
    v_mul_f32 v118, s48, v116
    v_mul_f32 v126, s48, v124
    v_mul_f32 v116, s48, v116
    v_mul_f32 v124, s48, v124
    s_nop 0
    v_permlane16_swap_b32 v116, v118
    v_permlane16_swap_b32 v124, v126
    v_mov_b32 v117, v116
    v_mov_b32 v125, v124
    v_mov_b32 v119, v118
    v_mov_b32 v127, v126
    v_permlane32_swap_b32 v116, v117
    v_permlane32_swap_b32 v124, v125
    v_permlane32_swap_b32 v118, v119
    v_permlane32_swap_b32 v126, v127
    v_fma_f32 v160, v160, s48, -v116
    v_fma_f32 v84, v84, s48, -v124
    v_fma_f32 v161, v161, s48, -v116
    v_fma_f32 v85, v85, s48, -v124
    v_fma_f32 v162, v162, s48, -v116
    v_fma_f32 v86, v86, s48, -v124
    v_fma_f32 v163, v163, s48, -v116
    v_fma_f32 v87, v87, s48, -v124
    v_exp_f32 v160, v160
    v_exp_f32 v84, v84
    v_exp_f32 v161, v161
    v_exp_f32 v85, v85
    v_exp_f32 v162, v162
    v_exp_f32 v86, v86
    v_exp_f32 v163, v163
    v_exp_f32 v87, v87
    v_perm_b32 v160, v160, v160, v6
    v_perm_b32 v84, v84, v84, v6
    v_perm_b32 v161, v161, v161, v6
    v_perm_b32 v85, v85, v85, v6
    v_perm_b32 v162, v162, v162, v6
    v_perm_b32 v86, v86, v86, v6
    v_perm_b32 v163, v163, v163, v6
    v_perm_b32 v87, v87, v87, v6
    v_fma_f32 v168, v168, s48, -v117
    v_fma_f32 v92, v92, s48, -v125
    v_fma_f32 v169, v169, s48, -v117
    v_fma_f32 v93, v93, s48, -v125
    v_fma_f32 v170, v170, s48, -v117
    v_mfma_f32_16x16x32_bf16 v[88:91], v[28:31], v[84:87], 0
    v_mfma_f32_16x16x32_bf16 v[164:167], v[28:31], v[160:163], 0
    v_fma_f32 v94, v94, s48, -v125
    v_fma_f32 v171, v171, s48, -v117
    v_fma_f32 v95, v95, s48, -v125
    v_exp_f32 v168, v168
    v_exp_f32 v92, v92
    v_exp_f32 v169, v169
    v_exp_f32 v93, v93
    v_exp_f32 v170, v170
    v_mfma_f32_16x16x32_bf16 v[128:131], v[66:69], v[84:87], 0
    v_mfma_f32_16x16x32_bf16 v[32:35], v[74:77], v[160:163], 0
    v_exp_f32 v94, v94
    v_exp_f32 v171, v171
    v_exp_f32 v95, v95
    v_perm_b32 v168, v168, v168, v6
    v_perm_b32 v92, v92, v92, v6
    v_perm_b32 v169, v169, v169, v6
    v_perm_b32 v93, v93, v93, v6
    v_perm_b32 v170, v170, v170, v6
    v_perm_b32 v94, v94, v94, v6
    v_perm_b32 v171, v171, v171, v6
    v_perm_b32 v95, v95, v95, v6
    v_fma_f32 v176, v176, s48, -v118
    v_fma_f32 v100, v100, s48, -v126
    v_fma_f32 v177, v177, s48, -v118
    v_fma_f32 v101, v101, s48, -v126
    v_fma_f32 v178, v178, s48, -v118
    v_mfma_f32_16x16x32_bf16 v[96:99], v[28:31], v[92:95], 0
    v_mfma_f32_16x16x32_bf16 v[172:175], v[28:31], v[168:171], 0
    v_fma_f32 v102, v102, s48, -v126
    v_fma_f32 v179, v179, s48, -v118
    v_fma_f32 v103, v103, s48, -v126
    buffer_load_dword v2, v1, s[32:35], s80 offen sc1
    v_exp_f32 v176, v176
    v_exp_f32 v100, v100
    v_exp_f32 v177, v177
    v_exp_f32 v101, v101
    v_exp_f32 v178, v178
    v_mfma_f32_16x16x32_bf16 v[132:135], v[68:71], v[92:95], 0
    v_mfma_f32_16x16x32_bf16 v[36:39], v[76:79], v[168:171], 0
    v_exp_f32 v102, v102
    v_exp_f32 v179, v179
    v_exp_f32 v103, v103
    v_perm_b32 v176, v176, v176, v6
    v_perm_b32 v100, v100, v100, v6
    v_perm_b32 v177, v177, v177, v6
    v_perm_b32 v101, v101, v101, v6
    v_perm_b32 v178, v178, v178, v6
    v_perm_b32 v102, v102, v102, v6
    v_perm_b32 v179, v179, v179, v6
    v_perm_b32 v103, v103, v103, v6
    v_fma_f32 v184, v184, s48, -v119
    v_fma_f32 v108, v108, s48, -v127
    v_fma_f32 v185, v185, s48, -v119
    v_fma_f32 v109, v109, s48, -v127
    v_fma_f32 v186, v186, s48, -v119
    v_mfma_f32_16x16x32_bf16 v[104:107], v[28:31], v[100:103], 0
    v_mfma_f32_16x16x32_bf16 v[180:183], v[28:31], v[176:179], 0
    v_fma_f32 v110, v110, s48, -v127
    v_fma_f32 v187, v187, s48, -v119
    v_fma_f32 v111, v111, s48, -v127
    v_exp_f32 v184, v184
    v_exp_f32 v108, v108
    v_exp_f32 v185, v185
    v_exp_f32 v109, v109
    v_exp_f32 v186, v186
    v_mfma_f32_16x16x32_bf16 v[136:139], v[70:73], v[100:103], 0
    v_mfma_f32_16x16x32_bf16 v[40:43], v[78:81], v[176:179], 0
    v_exp_f32 v110, v110
    v_exp_f32 v187, v187
    v_exp_f32 v111, v111
    v_perm_b32 v184, v184, v184, v6
    v_perm_b32 v108, v108, v108, v6
    v_perm_b32 v185, v185, v185, v6
    v_perm_b32 v109, v109, v109, v6
    v_perm_b32 v186, v186, v186, v6
    v_perm_b32 v110, v110, v110, v6
    v_perm_b32 v187, v187, v187, v6
    v_perm_b32 v111, v111, v111, v6
    s_nop 0
    v_mfma_f32_16x16x32_bf16 v[188:191], v[28:31], v[184:187], 0
    v_mfma_f32_16x16x32_bf16 v[112:115], v[28:31], v[108:111], 0
    v_mfma_f32_16x16x32_bf16 v[44:47], v[80:83], v[184:187], 0
    v_mfma_f32_16x16x32_bf16 v[140:143], v[72:75], v[108:111], 0
    v_rcp_f32 v164, v164
    v_rcp_f32 v88, v88
    v_rcp_f32 v172, v172
    v_rcp_f32 v96, v96
    v_pk_mul_f32 v[32:33], v[32:33], v[164:165] op_sel_hi:[1,0]
    v_pk_mul_f32 v[128:129], v[128:129], v[88:89] op_sel_hi:[1,0]
    v_pk_mul_f32 v[34:35], v[34:35], v[164:165] op_sel_hi:[1,0]
    v_pk_mul_f32 v[130:131], v[130:131], v[88:89] op_sel_hi:[1,0]
    v_cvt_pk_bf16_f32 v152, v32, v33
    v_cvt_pk_bf16_f32 v144, v128, v129
    v_cvt_pk_bf16_f32 v153, v34, v35
    v_cvt_pk_bf16_f32 v145, v130, v131
    v_rcp_f32 v180, v180
    v_rcp_f32 v104, v104
    v_pk_mul_f32 v[36:37], v[36:37], v[172:173] op_sel_hi:[1,0]
    v_pk_mul_f32 v[132:133], v[132:133], v[96:97] op_sel_hi:[1,0]
    v_pk_mul_f32 v[38:39], v[38:39], v[172:173] op_sel_hi:[1,0]
    v_pk_mul_f32 v[134:135], v[134:135], v[96:97] op_sel_hi:[1,0]
    v_cvt_pk_bf16_f32 v154, v36, v37
    v_cvt_pk_bf16_f32 v146, v132, v133
    v_cvt_pk_bf16_f32 v155, v38, v39
    v_cvt_pk_bf16_f32 v147, v134, v135
    v_rcp_f32 v188, v188
    v_rcp_f32 v112, v112
    v_pk_mul_f32 v[40:41], v[40:41], v[180:181] op_sel_hi:[1,0]
    v_pk_mul_f32 v[136:137], v[136:137], v[104:105] op_sel_hi:[1,0]
    v_pk_mul_f32 v[42:43], v[42:43], v[180:181] op_sel_hi:[1,0]
    v_pk_mul_f32 v[138:139], v[138:139], v[104:105] op_sel_hi:[1,0]
    v_cvt_pk_bf16_f32 v156, v40, v41
    v_cvt_pk_bf16_f32 v148, v136, v137
    v_cvt_pk_bf16_f32 v157, v42, v43
    v_cvt_pk_bf16_f32 v149, v138, v139
    v_pk_mul_f32 v[44:45], v[44:45], v[188:189] op_sel_hi:[1,0]
    v_pk_mul_f32 v[140:141], v[140:141], v[112:113] op_sel_hi:[1,0]
    v_pk_mul_f32 v[46:47], v[46:47], v[188:189] op_sel_hi:[1,0]
    v_pk_mul_f32 v[142:143], v[142:143], v[112:113] op_sel_hi:[1,0]
    v_cvt_pk_bf16_f32 v158, v44, v45
    v_cvt_pk_bf16_f32 v150, v140, v141
    v_cvt_pk_bf16_f32 v159, v46, v47
    v_cvt_pk_bf16_f32 v151, v142, v143
    v_permlane16_swap_b32 v152, v154
    v_permlane16_swap_b32 v144, v146
    v_permlane16_swap_b32 v153, v155
    v_permlane16_swap_b32 v145, v147
    v_permlane16_swap_b32 v156, v158
    v_permlane16_swap_b32 v148, v150
    v_permlane16_swap_b32 v157, v159
    v_permlane16_swap_b32 v149, v151
    s_waitcnt lgkmcnt(0)
    s_mul_i32 s49, s49, 0x9e3779b1
    s_add_u32 s49, s49, 0x7f4a7c15
    s_setprio 3
    s_waitcnt vmcnt(0)
    v_cmp_ne_u32 vcc, s49, v2
    s_nop 1
    s_cbranch_vccnz L_poll2
    buffer_load_dword v120, v5, s[32:35], s83 offen sc1
    buffer_load_dword v122, v5, s[32:35], s82 offen sc1
    buffer_load_dwordx4 v[116:119], v14, s[32:35], s84 offen sc1
    buffer_load_dwordx4 v[160:163], v14, s[32:35], s72 offen sc1
    buffer_load_dwordx4 v[112:115], v14, s[32:35], s81 offen sc1
    s_mov_b64 exec, s[100:101]
    buffer_load_dwordx4 v[192:195], v15, s[32:35], s72 offen offset:0 sc1
    buffer_load_dwordx4 v[196:199], v15, s[32:35], s72 offen offset:256 sc1
    s_mov_b64 exec, -1
    buffer_load_dwordx4 v[164:167], v14, s[32:35], s73 offen sc1
    s_mov_b64 exec, s[100:101]
    buffer_load_dwordx4 v[200:203], v15, s[32:35], s73 offen offset:0 sc1
    buffer_load_dwordx4 v[204:207], v15, s[32:35], s73 offen offset:256 sc1
    s_mov_b64 exec, -1
    buffer_load_dwordx4 v[168:171], v14, s[32:35], s74 offen sc1
    s_mov_b64 exec, s[100:101]
    buffer_load_dwordx4 v[208:211], v15, s[32:35], s74 offen offset:0 sc1
    buffer_load_dwordx4 v[212:215], v15, s[32:35], s74 offen offset:256 sc1
    s_mov_b64 exec, -1
    s_branch L_qkv_done
    .p2align 12
L_ob_late:
    s_mov_b32 s70, 0
L_ob_poll:
    buffer_load_dword v19, v18, s[32:35], 0 offen sc1
    s_add_u32 s70, s70, 1
    s_cmp_gt_u32 s70, 65536
    s_waitcnt vmcnt(0)
    v_cmp_ne_u32 vcc, s49, v19
    s_cbranch_scc1 L_ob_poll_x
    s_nop 0
    s_cbranch_vccnz L_ob_poll
L_ob_poll_x:
    s_branch L_ob_ok
L_fallback:
    s_lshl_b32 s51, s44, 16
    s_add_u32 s52, s51, 2097152
    s_mov_b32 s54, s52
    s_add_u32 s55, s52, 65536
    ds_read_b128 v[116:119], v27 offset:24576
    v_and_b32 v15, 0xfffffeff, v15
    v_mov_b32 v3, 0xff800000
    s_mov_b32 s53, s52
    v_and_b32 v1, 27, v0
    v_cmp_eq_u32 vcc, 16, v1
    v_mov_b32 v2, 0x3f803f80
    s_nop 0
    v_cndmask_b32 v2, 0, v2, vcc
    v_mov_b32 v88, v2
    v_mov_b32 v89, v2
    v_mov_b32 v90, v2
    v_mov_b32 v91, v2
    v_mov_b32 v92, v2
    v_mov_b32 v93, v2
    v_mov_b32 v94, v2
    v_mov_b32 v95, v2
L_fb1:
    buffer_load_dwordx4 v[84:87], v14, s[32:35], s53 offen sc1
    s_add_u32 s53, s53, 1024
    s_waitcnt vmcnt(0) lgkmcnt(0)
    v_mfma_f32_32x32x16_bf16 v[32:47], v[84:87], v[116:119], 0
    s_nop 11
    v_max3_f32 v4, v32, v33, v34
    v_max3_f32 v5, v35, v36, v37
    v_max3_f32 v4, v4, v38, v39
    v_max3_f32 v5, v5, v40, v41
    v_max3_f32 v4, v4, v42, v43
    v_max3_f32 v5, v5, v44, v45
    v_max3_f32 v4, v4, v46, v47
    v_max_f32 v4, v4, v5
    v_max_f32 v3, v3, v4
    s_cmp_lt_u32 s53, s55
    s_cbranch_scc1 L_fb1
    v_mov_b32 v4, v3
    s_nop 1
    v_permlane32_swap_b32 v3, v4
    v_max_f32 v3, v3, v4
    v_sub_f32 v96, 0, v3
    v_mov_b32 v64, 0
    v_sub_f32 v97, 0, v3
    v_mov_b32 v65, 0
    v_sub_f32 v98, 0, v3
    v_mov_b32 v66, 0
    v_sub_f32 v99, 0, v3
    v_mov_b32 v67, 0
    v_sub_f32 v100, 0, v3
    v_mov_b32 v68, 0
    v_sub_f32 v101, 0, v3
    v_mov_b32 v69, 0
    v_sub_f32 v102, 0, v3
    v_mov_b32 v70, 0
    v_sub_f32 v103, 0, v3
    v_mov_b32 v71, 0
    v_sub_f32 v104, 0, v3
    v_mov_b32 v72, 0
    v_sub_f32 v105, 0, v3
    v_mov_b32 v73, 0
    v_sub_f32 v106, 0, v3
    v_mov_b32 v74, 0
    v_sub_f32 v107, 0, v3
    v_mov_b32 v75, 0
    v_sub_f32 v108, 0, v3
    v_mov_b32 v76, 0
    v_sub_f32 v109, 0, v3
    v_mov_b32 v77, 0
    v_sub_f32 v110, 0, v3
    v_mov_b32 v78, 0
    v_sub_f32 v111, 0, v3
    v_mov_b32 v79, 0
L_fb2:
    buffer_load_dwordx4 v[84:87], v14, s[32:35], s52 offen sc1
    s_mov_b64 exec, s[100:101]
    buffer_load_dwordx4 v[88:91], v15, s[32:35], s54 offen sc1
    buffer_load_dwordx4 v[92:95], v15, s[32:35], s54 offen offset:256 sc1
    s_mov_b64 exec, -1
    s_add_u32 s52, s52, 1024
    s_add_u32 s54, s54, 1024
    s_waitcnt vmcnt(0)
    v_mfma_f32_32x32x16_bf16 v[32:47], v[84:87], v[116:119], v[96:111]
    s_nop 11
    v_exp_f32 v32, v32
    v_exp_f32 v33, v33
    v_exp_f32 v34, v34
    v_exp_f32 v35, v35
    v_exp_f32 v36, v36
    v_exp_f32 v37, v37
    v_exp_f32 v38, v38
    v_exp_f32 v39, v39
    v_exp_f32 v40, v40
    v_exp_f32 v41, v41
    v_exp_f32 v42, v42
    v_exp_f32 v43, v43
    v_exp_f32 v44, v44
    v_exp_f32 v45, v45
    v_exp_f32 v46, v46
    v_exp_f32 v47, v47
    v_smfmac_f32_32x32x32_bf16 v[64:79], v[88:91], v[32:39], v31
    s_nop 0
    v_smfmac_f32_32x32x32_bf16 v[64:79], v[92:95], v[40:47], v31
    s_cmp_lt_u32 s52, s55
    s_nop 7
    s_nop 7
    s_cbranch_scc1 L_fb2
    v_rcp_f32 v6, v72
    s_branch L_att_ok
    .fill (888-(.-L_ob_late))/4, 4, 0xbf800000
L_qkv_done:
    s_mov_b32 s28, s14
    s_mov_b32 s29, s15
    s_mov_b32 s30, 524288
    s_mov_b32 s31, 0x20000
    s_mov_b32 m0, s67
    v_mov_b32 v16, s49
    s_lshl_b32 s52, s40, 10
    v_mov_b32 v18, v11
    v_mov_b32 v124, v12
    v_add_u32 v20, s52, v14
    v_mov_b32 v31, 0xdddd
    v_mov_b32 v126, 0
    v_mov_b32 v127, 0
    v_mov_b32 v121, 0
    v_mov_b32 v123, 0
    v_mov_b32 v125, 0
    v_mfma_f32_32x32x8_bf16 v[64:79], v[126:127], v[126:127], 0
    v_mfma_f32_32x32x8_bf16 v[80:95], v[126:127], v[126:127], 0
    v_xor_b32 v21, 1024, v20
    v_xor_b32 v22, 2048, v20
    v_xor_b32 v23, 3072, v20
    v_xor_b32 v24, 4096, v20
    v_xor_b32 v25, 5120, v20
    v_xor_b32 v26, 6144, v20
    v_xor_b32 v27, 7168, v20
    s_add_u32 s54, s71, 5242880
    s_xor_b32 s53, s40, 7
    s_lshl3_add_u32 s53, s45, s53
    s_lshr_b32 s55, s53, 2
    s_lshl4_add_u32 s55, s44, s55
    s_lshl_b32 s55, s55, 9
    s_add_u32 s55, s55, 13631488
    s_and_b32 s52, s53, 1
    s_lshl_b32 s52, s52, 8
    s_add_u32 s55, s55, s52
    s_and_b32 s53, s53, 2
    s_lshl1_add_u32 s55, s53, s55
    v_and_b32 v12, 31, v0
    v_lshlrev_b32 v12, 3, v12
    v_lshlrev_b32 v30, 3, v0
L_att_go:
    s_setprio 3
    s_waitcnt vmcnt(11)
    v_mfma_f32_32x32x8_bf16 v[96:111], v[124:125], v[120:121], 0
    ds_write_b32 v20, v120 offset:16388
    v_mfma_f32_32x32x8_bf16 v[128:143], v[124:125], v[122:123], 0
    ds_write_b32 v20, v126 offset:16392
    v_mov_b32 v2, -1
    v_mov_b32 v3, -1
    v_mov_b32 v4, -1
    v_mov_b32 v5, -1
    s_waitcnt vmcnt(9)
    s_nop 1
    v_mfma_f32_32x32x16_bf16 v[32:47], v[160:163], v[116:119], v[96:111]
    ds_write_b128 v20, v[116:119] offset:24576
    s_setprio 1
    s_nop 9
    v_exp_f32 v32, v32
    v_exp_f32 v33, v33
    v_exp_f32 v34, v34
    v_exp_f32 v35, v35
    v_exp_f32 v36, v36
    s_waitcnt vmcnt(6)
    v_mfma_f32_32x32x16_bf16 v[48:63], v[160:163], v[112:115], v[128:143]
    v_exp_f32 v37, v37
    v_exp_f32 v38, v38
    v_exp_f32 v39, v39
    v_exp_f32 v40, v40
    buffer_load_dwordx4 v[172:175], v14, s[32:35], s75 offen sc1
    v_exp_f32 v41, v41
    v_exp_f32 v42, v42
    v_smfmac_f32_32x32x32_bf16 v[64:79], v[192:195], v[32:39], v31
    v_exp_f32 v43, v43
    v_exp_f32 v44, v44
    v_exp_f32 v45, v45
    s_mov_b64 exec, s[100:101]
    buffer_load_dwordx4 v[216:219], v15, s[32:35], s75 offen offset:0 sc1
    buffer_load_dwordx4 v[220:223], v15, s[32:35], s75 offen offset:256 sc1
    s_mov_b64 exec, -1
    v_exp_f32 v46, v46
    v_exp_f32 v47, v47
    v_exp_f32 v48, v48
    v_exp_f32 v49, v49
    v_smfmac_f32_32x32x32_bf16 v[64:79], v[196:199], v[40:47], v31
    v_exp_f32 v50, v50
    v_exp_f32 v51, v51
    v_exp_f32 v52, v52
    s_waitcnt vmcnt(8)
    v_mfma_f32_32x32x16_bf16 v[32:47], v[164:167], v[116:119], v[96:111]
    v_exp_f32 v53, v53
    v_exp_f32 v54, v54
    v_exp_f32 v55, v55
    v_exp_f32 v56, v56
    v_exp_f32 v57, v57
    v_exp_f32 v58, v58
    v_smfmac_f32_32x32x32_bf16 v[80:95], v[192:195], v[48:55], v31
    v_exp_f32 v59, v59
    v_exp_f32 v60, v60
    v_exp_f32 v61, v61
    v_exp_f32 v62, v62
    v_exp_f32 v63, v63
    v_exp_f32 v32, v32
    v_exp_f32 v33, v33
    v_smfmac_f32_32x32x32_bf16 v[80:95], v[196:199], v[56:63], v31
    v_exp_f32 v34, v34
    v_exp_f32 v35, v35
    v_exp_f32 v36, v36
    s_waitcnt vmcnt(6)
    v_mfma_f32_32x32x16_bf16 v[48:63], v[164:167], v[112:115], v[128:143]
    v_exp_f32 v37, v37
    v_exp_f32 v38, v38
    v_exp_f32 v39, v39
    v_exp_f32 v40, v40
    buffer_load_dwordx4 v[176:179], v14, s[32:35], s76 offen sc1
    v_exp_f32 v41, v41
    v_exp_f32 v42, v42
    v_smfmac_f32_32x32x32_bf16 v[64:79], v[200:203], v[32:39], v31
    v_exp_f32 v43, v43
    v_exp_f32 v44, v44
    v_exp_f32 v45, v45
    s_mov_b64 exec, s[100:101]
    buffer_load_dwordx4 v[224:227], v15, s[32:35], s76 offen offset:0 sc1
    buffer_load_dwordx4 v[228:231], v15, s[32:35], s76 offen offset:256 sc1
    s_mov_b64 exec, -1
    v_exp_f32 v46, v46
    v_exp_f32 v47, v47
    v_exp_f32 v48, v48
    v_exp_f32 v49, v49
    v_smfmac_f32_32x32x32_bf16 v[64:79], v[204:207], v[40:47], v31
    v_exp_f32 v50, v50
    v_exp_f32 v51, v51
    v_exp_f32 v52, v52
    s_waitcnt vmcnt(8)
    v_mfma_f32_32x32x16_bf16 v[32:47], v[168:171], v[116:119], v[96:111]
    v_exp_f32 v53, v53
    v_exp_f32 v54, v54
    v_exp_f32 v55, v55
    v_exp_f32 v56, v56
    v_exp_f32 v57, v57
    v_exp_f32 v58, v58
    v_smfmac_f32_32x32x32_bf16 v[80:95], v[200:203], v[48:55], v31
    v_exp_f32 v59, v59
    v_exp_f32 v60, v60
    v_exp_f32 v61, v61
    v_exp_f32 v62, v62
    v_exp_f32 v63, v63
    v_exp_f32 v32, v32
    v_exp_f32 v33, v33
    v_smfmac_f32_32x32x32_bf16 v[80:95], v[204:207], v[56:63], v31
    v_exp_f32 v34, v34
    v_exp_f32 v35, v35
    v_exp_f32 v36, v36
    s_waitcnt vmcnt(6)
    v_mfma_f32_32x32x16_bf16 v[48:63], v[168:171], v[112:115], v[128:143]
    v_exp_f32 v37, v37
    v_exp_f32 v38, v38
    v_exp_f32 v39, v39
    v_exp_f32 v40, v40
    buffer_load_dwordx4 v[180:183], v14, s[32:35], s77 offen sc1
    v_exp_f32 v41, v41
    v_exp_f32 v42, v42
    v_smfmac_f32_32x32x32_bf16 v[64:79], v[208:211], v[32:39], v31
    v_exp_f32 v43, v43
    v_exp_f32 v44, v44
    v_exp_f32 v45, v45
    s_mov_b64 exec, s[100:101]
    buffer_load_dwordx4 v[232:235], v15, s[32:35], s77 offen offset:0 sc1
    buffer_load_dwordx4 v[236:239], v15, s[32:35], s77 offen offset:256 sc1
    s_mov_b64 exec, -1
    v_exp_f32 v46, v46
    v_exp_f32 v47, v47
    v_exp_f32 v48, v48
    v_exp_f32 v49, v49
    v_smfmac_f32_32x32x32_bf16 v[64:79], v[212:215], v[40:47], v31
    v_exp_f32 v50, v50
    v_exp_f32 v51, v51
    v_exp_f32 v52, v52
    s_waitcnt vmcnt(8)
    v_mfma_f32_32x32x16_bf16 v[32:47], v[172:175], v[116:119], v[96:111]
    v_exp_f32 v53, v53
    v_exp_f32 v54, v54
    v_exp_f32 v55, v55
    v_exp_f32 v56, v56
    v_exp_f32 v57, v57
    v_exp_f32 v58, v58
    v_smfmac_f32_32x32x32_bf16 v[80:95], v[208:211], v[48:55], v31
    v_exp_f32 v59, v59
    v_exp_f32 v60, v60
    v_exp_f32 v61, v61
    v_exp_f32 v62, v62
    v_exp_f32 v63, v63
    v_exp_f32 v32, v32
    v_exp_f32 v33, v33
    v_smfmac_f32_32x32x32_bf16 v[80:95], v[212:215], v[56:63], v31
    v_exp_f32 v34, v34
    v_exp_f32 v35, v35
    v_exp_f32 v36, v36
    s_waitcnt vmcnt(5)
    v_mfma_f32_32x32x16_bf16 v[48:63], v[176:179], v[116:119], v[96:111]
    v_exp_f32 v37, v37
    v_exp_f32 v38, v38
    v_exp_f32 v39, v39
    v_exp_f32 v40, v40
    buffer_load_dwordx4 v[184:187], v14, s[32:35], s78 offen sc1
    v_exp_f32 v41, v41
    v_exp_f32 v42, v42
    v_smfmac_f32_32x32x32_bf16 v[64:79], v[216:219], v[32:39], v31
    v_exp_f32 v43, v43
    v_exp_f32 v44, v44
    v_exp_f32 v45, v45
    s_mov_b64 exec, s[100:101]
    buffer_load_dwordx4 v[240:243], v15, s[32:35], s78 offen offset:0 sc1
    buffer_load_dwordx4 v[244:247], v15, s[32:35], s78 offen offset:256 sc1
    s_mov_b64 exec, -1
    v_exp_f32 v46, v46
    v_exp_f32 v47, v47
    v_exp_f32 v48, v48
    v_exp_f32 v49, v49
    v_smfmac_f32_32x32x32_bf16 v[64:79], v[220:223], v[40:47], v31
    v_exp_f32 v50, v50
    v_exp_f32 v51, v51
    v_exp_f32 v52, v52
    s_waitcnt vmcnt(5)
    v_mfma_f32_32x32x16_bf16 v[32:47], v[180:183], v[116:119], v[96:111]
    v_exp_f32 v53, v53
    v_exp_f32 v54, v54
    v_exp_f32 v55, v55
    v_exp_f32 v56, v56
    s_setprio 0
    v_exp_f32 v57, v57
    v_exp_f32 v58, v58
    v_smfmac_f32_32x32x32_bf16 v[64:79], v[224:227], v[48:55], v31
    v_exp_f32 v59, v59
    v_exp_f32 v60, v60
    v_exp_f32 v61, v61
    v_exp_f32 v62, v62
    v_exp_f32 v63, v63
    v_exp_f32 v32, v32
    v_exp_f32 v33, v33
    v_smfmac_f32_32x32x32_bf16 v[64:79], v[228:231], v[56:63], v31
    v_exp_f32 v34, v34
    v_exp_f32 v35, v35
    v_exp_f32 v36, v36
    s_waitcnt vmcnt(2)
    v_mfma_f32_32x32x16_bf16 v[48:63], v[184:187], v[116:119], v[96:111]
    v_exp_f32 v37, v37
    v_exp_f32 v38, v38
    v_exp_f32 v39, v39
    v_exp_f32 v40, v40
    v_exp_f32 v41, v41
    v_exp_f32 v42, v42
    v_smfmac_f32_32x32x32_bf16 v[64:79], v[232:235], v[32:39], v31
    v_exp_f32 v43, v43
    v_exp_f32 v44, v44
    v_exp_f32 v45, v45
    v_exp_f32 v46, v46
    v_exp_f32 v47, v47
    v_exp_f32 v48, v48
    v_exp_f32 v49, v49
    v_smfmac_f32_32x32x32_bf16 v[64:79], v[236:239], v[40:47], v31
    v_exp_f32 v50, v50
    v_exp_f32 v51, v51
    v_exp_f32 v52, v52
    s_waitcnt vmcnt(0)
    v_mfma_f32_32x32x16_bf16 v[32:47], v[172:175], v[112:115], v[128:143]
    v_exp_f32 v53, v53
    v_exp_f32 v54, v54
    s_cmp_eq_u32 s63, 0
    s_cbranch_scc1 L_nopl
    buffer_store_dwordx2 v[28:29], v30, s[32:35], s63 offen sc1
L_nopl:
    v_exp_f32 v55, v55
    v_exp_f32 v56, v56
    s_cmp_eq_u32 s23, 0
    s_cbranch_scc1 L_nost0
    s_add_u32 s51, s50, 32768
    buffer_store_dwordx4 v[144:147], v14, s[32:35], s50 offen sc1
    buffer_store_dwordx4 v[148:151], v14, s[32:35], s51 offen sc1
    s_add_u32 s50, s50, 65536
L_nost0:
    v_exp_f32 v57, v57
    v_exp_f32 v58, v58
    v_smfmac_f32_32x32x32_bf16 v[64:79], v[240:243], v[48:55], v31
    v_exp_f32 v59, v59
    v_exp_f32 v60, v60
    s_cmp_eq_u32 s23, 0
    s_cbranch_scc1 L_nost1
    s_add_u32 s51, s50, 32768
    buffer_store_dwordx4 v[152:155], v14, s[32:35], s50 offen sc1
    buffer_store_dwordx4 v[156:159], v14, s[32:35], s51 offen sc1
    s_add_u32 s50, s50, 65536
L_nost1:
    v_exp_f32 v61, v61
    v_exp_f32 v62, v62
    buffer_store_dwordx4 v[2:5], v14, s[32:35], s71 offen sc1
    v_exp_f32 v63, v63
    v_exp_f32 v32, v32
    v_exp_f32 v33, v33
    v_smfmac_f32_32x32x32_bf16 v[64:79], v[244:247], v[56:63], v31
    v_exp_f32 v34, v34
    v_exp_f32 v35, v35
    v_exp_f32 v36, v36
    v_mfma_f32_32x32x16_bf16 v[48:63], v[176:179], v[112:115], v[128:143]
    v_exp_f32 v37, v37
    v_exp_f32 v38, v38
    v_exp_f32 v39, v39
    v_exp_f32 v40, v40
    v_exp_f32 v41, v41
    v_exp_f32 v42, v42
    v_smfmac_f32_32x32x32_bf16 v[80:95], v[216:219], v[32:39], v31
    v_exp_f32 v43, v43
    v_exp_f32 v44, v44
    v_exp_f32 v45, v45
    v_exp_f32 v46, v46
    ds_write_b128 v20, v[64:67] offset:0
    v_exp_f32 v47, v47
    v_exp_f32 v48, v48
    ds_write_b128 v20, v[68:71] offset:8192
    v_exp_f32 v49, v49
    v_smfmac_f32_32x32x32_bf16 v[80:95], v[220:223], v[40:47], v31
    v_exp_f32 v50, v50
    ds_write_b32 v20, v72 offset:16384
    v_exp_f32 v51, v51
    v_exp_f32 v52, v52
    v_mfma_f32_32x32x16_bf16 v[32:47], v[180:183], v[112:115], v[128:143]
    v_exp_f32 v53, v53
    v_exp_f32 v54, v54
    v_exp_f32 v55, v55
    s_waitcnt lgkmcnt(0)
    s_setprio 3
    s_barrier
    v_exp_f32 v56, v56
    v_exp_f32 v57, v57
    v_exp_f32 v58, v58
    v_smfmac_f32_32x32x32_bf16 v[80:95], v[224:227], v[48:55], v31
    v_exp_f32 v59, v59
    v_exp_f32 v60, v60
    v_exp_f32 v61, v61
    ds_read_b32 v120, v22 offset:16388
    v_exp_f32 v62, v62
    v_exp_f32 v63, v63
    ds_read_b128 v[116:119], v22 offset:24576
    v_exp_f32 v32, v32
    v_exp_f32 v33, v33
    v_smfmac_f32_32x32x32_bf16 v[80:95], v[228:231], v[56:63], v31
    v_exp_f32 v34, v34
    v_exp_f32 v35, v35
    v_exp_f32 v36, v36
    v_mfma_f32_32x32x16_bf16 v[48:63], v[184:187], v[112:115], v[128:143]
    v_exp_f32 v37, v37
    v_exp_f32 v38, v38
    v_exp_f32 v39, v39
    v_exp_f32 v40, v40
    ds_read_b128 v[64:67], v22 offset:0
    v_exp_f32 v41, v41
    v_exp_f32 v42, v42
    v_smfmac_f32_32x32x32_bf16 v[80:95], v[232:235], v[32:39], v31
    v_exp_f32 v43, v43
    v_exp_f32 v44, v44
    s_waitcnt lgkmcnt(2)
    v_exp_f32 v45, v45
    v_mfma_f32_32x32x8_bf16 v[96:111], v[124:125], v[120:121], 0
    v_exp_f32 v46, v46
    v_exp_f32 v47, v47
    ds_read_b128 v[68:71], v22 offset:8192
    v_exp_f32 v48, v48
    v_exp_f32 v49, v49
    v_smfmac_f32_32x32x32_bf16 v[80:95], v[236:239], v[40:47], v31
    v_exp_f32 v50, v50
    v_exp_f32 v51, v51
    s_waitcnt lgkmcnt(2)
    v_exp_f32 v52, v52
    v_mfma_f32_32x32x16_bf16 v[32:47], v[160:163], v[116:119], v[96:111]
    v_exp_f32 v53, v53
    v_exp_f32 v54, v54
    v_exp_f32 v55, v55
    v_exp_f32 v56, v56
    ds_read_b32 v72, v22 offset:16384
    v_exp_f32 v57, v57
    v_exp_f32 v58, v58
    v_smfmac_f32_32x32x32_bf16 v[80:95], v[240:243], v[48:55], v31
    v_exp_f32 v59, v59
    v_exp_f32 v60, v60
    v_exp_f32 v61, v61
    v_exp_f32 v62, v62
    v_exp_f32 v63, v63
    v_exp_f32 v32, v32
    v_exp_f32 v33, v33
    v_smfmac_f32_32x32x32_bf16 v[80:95], v[244:247], v[56:63], v31
    v_exp_f32 v34, v34
    s_xor_b32 s52, s85, 0
    v_exp_f32 v35, v35
    v_exp_f32 v36, v36
    v_mfma_f32_32x32x16_bf16 v[48:63], v[164:167], v[116:119], v[96:111]
    v_exp_f32 v37, v37
    v_exp_f32 v38, v38
    v_exp_f32 v39, v39
    v_exp_f32 v40, v40
    s_waitcnt lgkmcnt(0)
    v_exp_f32 v41, v41
    v_exp_f32 v42, v42
    v_smfmac_f32_32x32x32_bf16 v[64:79], v[192:195], v[32:39], v31
    v_exp_f32 v43, v43
    v_exp_f32 v44, v44
    v_exp_f32 v45, v45
    buffer_load_dwordx4 v13, s[28:31], s52 offen lds
    v_exp_f32 v46, v46
    v_exp_f32 v47, v47
    s_setprio 2
    s_add_u32 m0, m0, 8192
    v_exp_f32 v48, v48
    v_exp_f32 v49, v49
    v_smfmac_f32_32x32x32_bf16 v[64:79], v[196:199], v[40:47], v31
    v_exp_f32 v50, v50
    v_exp_f32 v51, v51
    v_exp_f32 v52, v52
    v_mfma_f32_32x32x16_bf16 v[32:47], v[168:171], v[116:119], v[96:111]
    v_exp_f32 v53, v53
    v_exp_f32 v54, v54
    v_exp_f32 v55, v55
    v_exp_f32 v56, v56
    s_waitcnt vmcnt(1)
    s_cmp_eq_u32 s23, 0
    s_mov_b64 exec, 1
    buffer_store_dword v16, v126, s[32:35], s3 offen sc1
    s_cbranch_scc1 L_nofl
    buffer_store_dword v16, v126, s[32:35], s23 offen sc1
L_nofl:
    s_mov_b64 exec, -1
    v_exp_f32 v57, v57
    v_exp_f32 v58, v58
    v_smfmac_f32_32x32x32_bf16 v[64:79], v[200:203], v[48:55], v31
    v_exp_f32 v59, v59
    v_exp_f32 v60, v60
    v_exp_f32 v61, v61
    v_exp_f32 v62, v62
    ds_write_b128 v22, v[80:83] offset:0
    v_exp_f32 v63, v63
    v_exp_f32 v32, v32
    v_exp_f32 v33, v33
    v_smfmac_f32_32x32x32_bf16 v[64:79], v[204:207], v[56:63], v31
    v_exp_f32 v34, v34
    s_xor_b32 s52, s85, 65536
    v_exp_f32 v35, v35
    v_exp_f32 v36, v36
    v_mfma_f32_32x32x16_bf16 v[48:63], v[172:175], v[116:119], v[96:111]
    v_exp_f32 v37, v37
    v_exp_f32 v38, v38
    v_exp_f32 v39, v39
    v_exp_f32 v40, v40
    v_exp_f32 v41, v41
    v_exp_f32 v42, v42
    v_smfmac_f32_32x32x32_bf16 v[64:79], v[208:211], v[32:39], v31
    v_exp_f32 v43, v43
    v_exp_f32 v44, v44
    v_exp_f32 v45, v45
    buffer_load_dwordx4 v13, s[28:31], s52 offen lds
    v_exp_f32 v46, v46
    ds_write_b128 v22, v[84:87] offset:8192
    v_exp_f32 v47, v47
    s_add_u32 m0, m0, 8192
    v_exp_f32 v48, v48
    v_exp_f32 v49, v49
    v_smfmac_f32_32x32x32_bf16 v[64:79], v[212:215], v[40:47], v31
    v_exp_f32 v50, v50
    s_setprio 1
    s_xor_b32 s52, s85, 131072
    v_exp_f32 v51, v51
    v_exp_f32 v52, v52
    v_mfma_f32_32x32x16_bf16 v[32:47], v[176:179], v[116:119], v[96:111]
    v_exp_f32 v53, v53
    v_exp_f32 v54, v54
    v_exp_f32 v55, v55
    v_exp_f32 v56, v56
    ds_write_b32 v22, v88 offset:16384
    v_exp_f32 v57, v57
    v_exp_f32 v58, v58
    v_smfmac_f32_32x32x32_bf16 v[64:79], v[216:219], v[48:55], v31
    v_exp_f32 v59, v59
    v_exp_f32 v60, v60
    v_exp_f32 v61, v61
    buffer_load_dwordx4 v13, s[28:31], s52 offen lds
    v_exp_f32 v62, v62
    v_exp_f32 v63, v63
    s_add_u32 m0, m0, 8192
    v_exp_f32 v32, v32
    s_setprio 0
    v_exp_f32 v33, v33
    v_smfmac_f32_32x32x32_bf16 v[64:79], v[220:223], v[56:63], v31
    v_exp_f32 v34, v34
    v_exp_f32 v35, v35
    v_exp_f32 v36, v36
    v_mfma_f32_32x32x16_bf16 v[48:63], v[180:183], v[116:119], v[96:111]
    v_exp_f32 v37, v37
    v_exp_f32 v38, v38
    v_exp_f32 v39, v39
    s_waitcnt lgkmcnt(0)
    s_setprio 3
    s_barrier
    v_exp_f32 v40, v40
    v_exp_f32 v41, v41
    v_exp_f32 v42, v42
    v_smfmac_f32_32x32x32_bf16 v[64:79], v[224:227], v[32:39], v31
    v_exp_f32 v43, v43
    v_exp_f32 v44, v44
    v_exp_f32 v45, v45
    ds_read_b32 v122, v23 offset:16388
    v_exp_f32 v46, v46
    v_exp_f32 v47, v47
    ds_read_b128 v[112:115], v23 offset:24576
    v_exp_f32 v48, v48
    v_exp_f32 v49, v49
    v_smfmac_f32_32x32x32_bf16 v[64:79], v[228:231], v[40:47], v31
    v_exp_f32 v50, v50
    v_exp_f32 v51, v51
    v_exp_f32 v52, v52
    v_mfma_f32_32x32x16_bf16 v[32:47], v[184:187], v[116:119], v[96:111]
    v_exp_f32 v53, v53
    v_exp_f32 v54, v54
    v_exp_f32 v55, v55
    v_exp_f32 v56, v56
    ds_read_b128 v[80:83], v20 offset:0
    v_exp_f32 v57, v57
    v_exp_f32 v58, v58
    v_smfmac_f32_32x32x32_bf16 v[64:79], v[232:235], v[48:55], v31
    v_exp_f32 v59, v59
    v_exp_f32 v60, v60
    s_waitcnt lgkmcnt(2)
    v_exp_f32 v61, v61
    v_mfma_f32_32x32x8_bf16 v[96:111], v[124:125], v[122:123], 0
    v_exp_f32 v62, v62
    v_exp_f32 v63, v63
    ds_read_b128 v[84:87], v20 offset:8192
    v_exp_f32 v32, v32
    v_exp_f32 v33, v33
    v_smfmac_f32_32x32x32_bf16 v[64:79], v[236:239], v[56:63], v31
    v_exp_f32 v34, v34
    s_xor_b32 s52, s85, 196608
    v_exp_f32 v35, v35
    s_waitcnt lgkmcnt(2)
    v_exp_f32 v36, v36
    v_mfma_f32_32x32x16_bf16 v[48:63], v[160:163], v[112:115], v[96:111]
    v_exp_f32 v37, v37
    v_exp_f32 v38, v38
    v_exp_f32 v39, v39
    v_exp_f32 v40, v40
    ds_read_b32 v88, v20 offset:16384
    v_exp_f32 v41, v41
    v_exp_f32 v42, v42
    v_smfmac_f32_32x32x32_bf16 v[64:79], v[240:243], v[32:39], v31
    v_exp_f32 v43, v43
    v_exp_f32 v44, v44
    v_exp_f32 v45, v45
    buffer_load_dwordx4 v13, s[28:31], s52 offen lds
    v_exp_f32 v46, v46
    v_exp_f32 v47, v47
    s_add_u32 m0, m0, 8192
    v_exp_f32 v48, v48
    v_exp_f32 v49, v49
    v_smfmac_f32_32x32x32_bf16 v[64:79], v[244:247], v[40:47], v31
    v_exp_f32 v50, v50
    s_xor_b32 s52, s85, 262144
    v_exp_f32 v51, v51
    v_exp_f32 v52, v52
    v_mfma_f32_32x32x16_bf16 v[32:47], v[164:167], v[112:115], v[96:111]
    v_exp_f32 v53, v53
    v_exp_f32 v54, v54
    v_exp_f32 v55, v55
    v_exp_f32 v56, v56
    buffer_load_dwordx4 v[188:191], v14, s[32:35], s79 offen sc1
    s_waitcnt lgkmcnt(0)
    v_exp_f32 v57, v57
    v_exp_f32 v58, v58
    v_smfmac_f32_32x32x32_bf16 v[80:95], v[192:195], v[48:55], v31
    v_exp_f32 v59, v59
    v_exp_f32 v60, v60
    v_exp_f32 v61, v61
    buffer_load_dwordx4 v13, s[28:31], s52 offen lds
    v_exp_f32 v62, v62
    v_exp_f32 v63, v63
    s_setprio 2
    s_add_u32 m0, m0, 8192
    v_exp_f32 v32, v32
    v_exp_f32 v33, v33
    v_smfmac_f32_32x32x32_bf16 v[80:95], v[196:199], v[56:63], v31
    v_exp_f32 v34, v34
    v_exp_f32 v35, v35
    v_exp_f32 v36, v36
    v_mfma_f32_32x32x16_bf16 v[48:63], v[168:171], v[112:115], v[96:111]
    v_exp_f32 v37, v37
    v_exp_f32 v38, v38
    v_exp_f32 v39, v39
    v_exp_f32 v40, v40
    s_mov_b64 exec, s[100:101]
    buffer_load_dwordx4 v[248:251], v15, s[32:35], s79 offen offset:0 sc1
    buffer_load_dwordx4 v[252:255], v15, s[32:35], s79 offen offset:256 sc1
    s_mov_b64 exec, -1
    v_exp_f32 v41, v41
    v_exp_f32 v42, v42
    v_smfmac_f32_32x32x32_bf16 v[80:95], v[200:203], v[32:39], v31
    v_exp_f32 v43, v43
    v_exp_f32 v44, v44
    v_exp_f32 v45, v45
    v_exp_f32 v46, v46
    ds_write_b128 v20, v[64:67] offset:0
    v_exp_f32 v47, v47
    v_exp_f32 v48, v48
    v_exp_f32 v49, v49
    v_smfmac_f32_32x32x32_bf16 v[80:95], v[204:207], v[40:47], v31
    v_exp_f32 v50, v50
    s_xor_b32 s52, s85, 327680
    v_exp_f32 v51, v51
    v_exp_f32 v52, v52
    v_mfma_f32_32x32x16_bf16 v[32:47], v[172:175], v[112:115], v[96:111]
    v_exp_f32 v53, v53
    v_exp_f32 v54, v54
    v_exp_f32 v55, v55
    v_exp_f32 v56, v56
    v_exp_f32 v57, v57
    v_exp_f32 v58, v58
    v_smfmac_f32_32x32x32_bf16 v[80:95], v[208:211], v[48:55], v31
    v_exp_f32 v59, v59
    v_exp_f32 v60, v60
    v_exp_f32 v61, v61
    buffer_load_dwordx4 v13, s[28:31], s52 offen lds
    v_exp_f32 v62, v62
    ds_write_b128 v20, v[68:71] offset:8192
    v_exp_f32 v63, v63
    s_add_u32 m0, m0, 8192
    v_exp_f32 v32, v32
    v_exp_f32 v33, v33
    v_smfmac_f32_32x32x32_bf16 v[80:95], v[212:215], v[56:63], v31
    v_exp_f32 v34, v34
    s_setprio 1
    s_xor_b32 s52, s85, 393216
    v_exp_f32 v35, v35
    v_exp_f32 v36, v36
    v_mfma_f32_32x32x16_bf16 v[48:63], v[176:179], v[112:115], v[96:111]
    v_exp_f32 v37, v37
    v_exp_f32 v38, v38
    v_exp_f32 v39, v39
    v_exp_f32 v40, v40
    ds_write_b32 v20, v72 offset:16384
    v_exp_f32 v41, v41
    v_exp_f32 v42, v42
    v_smfmac_f32_32x32x32_bf16 v[80:95], v[216:219], v[32:39], v31
    v_exp_f32 v43, v43
    v_exp_f32 v44, v44
    v_exp_f32 v45, v45
    buffer_load_dwordx4 v13, s[28:31], s52 offen lds
    v_exp_f32 v46, v46
    v_exp_f32 v47, v47
    s_add_u32 m0, m0, 8192
    v_exp_f32 v48, v48
    s_setprio 0
    v_exp_f32 v49, v49
    v_smfmac_f32_32x32x32_bf16 v[80:95], v[220:223], v[40:47], v31
    v_exp_f32 v50, v50
    v_exp_f32 v51, v51
    v_exp_f32 v52, v52
    v_mfma_f32_32x32x16_bf16 v[32:47], v[180:183], v[112:115], v[96:111]
    v_exp_f32 v53, v53
    v_exp_f32 v54, v54
    v_exp_f32 v55, v55
    s_waitcnt lgkmcnt(0)
    s_setprio 3
    s_barrier
    v_exp_f32 v56, v56
    v_exp_f32 v57, v57
    v_exp_f32 v58, v58
    v_smfmac_f32_32x32x32_bf16 v[80:95], v[224:227], v[48:55], v31
    v_exp_f32 v59, v59
    v_exp_f32 v60, v60
    v_exp_f32 v61, v61
    ds_read_b32 v120, v24 offset:16388
    v_exp_f32 v62, v62
    v_exp_f32 v63, v63
    ds_read_b128 v[116:119], v24 offset:24576
    v_exp_f32 v32, v32
    v_exp_f32 v33, v33
    v_smfmac_f32_32x32x32_bf16 v[80:95], v[228:231], v[56:63], v31
    v_exp_f32 v34, v34
    v_exp_f32 v35, v35
    v_exp_f32 v36, v36
    v_mfma_f32_32x32x16_bf16 v[48:63], v[184:187], v[112:115], v[96:111]
    v_exp_f32 v37, v37
    v_exp_f32 v38, v38
    v_exp_f32 v39, v39
    v_exp_f32 v40, v40
    ds_read_b128 v[64:67], v26 offset:0
    v_exp_f32 v41, v41
    v_exp_f32 v42, v42
    v_smfmac_f32_32x32x32_bf16 v[80:95], v[232:235], v[32:39], v31
    v_exp_f32 v43, v43
    v_exp_f32 v44, v44
    s_waitcnt lgkmcnt(2)
    v_exp_f32 v45, v45
    v_mfma_f32_32x32x8_bf16 v[96:111], v[124:125], v[120:121], 0
    v_exp_f32 v46, v46
    v_exp_f32 v47, v47
    ds_read_b128 v[68:71], v26 offset:8192
    v_exp_f32 v48, v48
    v_exp_f32 v49, v49
    v_smfmac_f32_32x32x32_bf16 v[80:95], v[236:239], v[40:47], v31
    v_exp_f32 v50, v50
    s_xor_b32 s52, s85, 458752
    v_exp_f32 v51, v51
    s_waitcnt lgkmcnt(2)
    v_exp_f32 v52, v52
    v_mfma_f32_32x32x16_bf16 v[32:47], v[160:163], v[116:119], v[96:111]
    v_exp_f32 v53, v53
    v_exp_f32 v54, v54
    v_exp_f32 v55, v55
    v_exp_f32 v56, v56
    ds_read_b32 v72, v26 offset:16384
    v_exp_f32 v57, v57
    v_exp_f32 v58, v58
    v_smfmac_f32_32x32x32_bf16 v[80:95], v[240:243], v[48:55], v31
    v_exp_f32 v59, v59
    v_exp_f32 v60, v60
    v_exp_f32 v61, v61
    buffer_load_dwordx4 v13, s[28:31], s52 offen lds
    v_exp_f32 v62, v62
    v_exp_f32 v63, v63
    s_add_u32 m0, m0, 8192
    v_exp_f32 v32, v32
    v_exp_f32 v33, v33
    v_smfmac_f32_32x32x32_bf16 v[80:95], v[244:247], v[56:63], v31
    s_mov_b64 s[28:29], s[8:9]
    v_exp_f32 v34, v34
    s_xor_b32 s52, s85, 0
    v_exp_f32 v35, v35
    v_exp_f32 v36, v36
    v_mfma_f32_32x32x16_bf16 v[48:63], v[164:167], v[116:119], v[96:111]
    v_exp_f32 v37, v37
    v_exp_f32 v38, v38
    v_exp_f32 v39, v39
    v_exp_f32 v40, v40
    s_waitcnt lgkmcnt(0)
    v_exp_f32 v41, v41
    v_exp_f32 v42, v42
    v_smfmac_f32_32x32x32_bf16 v[64:79], v[192:195], v[32:39], v31
    v_exp_f32 v43, v43
    v_exp_f32 v44, v44
    v_exp_f32 v45, v45
    buffer_load_dwordx4 v13, s[28:31], s52 offen lds
    v_exp_f32 v46, v46
    v_exp_f32 v47, v47
    s_add_u32 m0, m0, 8192
    v_exp_f32 v48, v48
    v_exp_f32 v49, v49
    v_smfmac_f32_32x32x32_bf16 v[64:79], v[196:199], v[40:47], v31
    v_exp_f32 v50, v50
    v_exp_f32 v51, v51
    v_exp_f32 v52, v52
    v_mfma_f32_32x32x16_bf16 v[32:47], v[168:171], v[116:119], v[96:111]
    v_exp_f32 v53, v53
    v_exp_f32 v54, v54
    v_exp_f32 v55, v55
    s_setprio 2
    v_exp_f32 v56, v56
    v_exp_f32 v57, v57
    v_exp_f32 v58, v58
    v_smfmac_f32_32x32x32_bf16 v[64:79], v[200:203], v[48:55], v31
    v_exp_f32 v59, v59
    v_exp_f32 v60, v60
    v_exp_f32 v61, v61
    v_exp_f32 v62, v62
    ds_write_b128 v26, v[80:83] offset:0
    v_exp_f32 v63, v63
    v_exp_f32 v32, v32
    v_exp_f32 v33, v33
    v_smfmac_f32_32x32x32_bf16 v[64:79], v[204:207], v[56:63], v31
    v_exp_f32 v34, v34
    s_xor_b32 s52, s85, 65536
    v_exp_f32 v35, v35
    v_exp_f32 v36, v36
    v_mfma_f32_32x32x16_bf16 v[48:63], v[172:175], v[116:119], v[96:111]
    v_exp_f32 v37, v37
    v_exp_f32 v38, v38
    v_exp_f32 v39, v39
    v_exp_f32 v40, v40
    v_exp_f32 v41, v41
    v_exp_f32 v42, v42
    v_smfmac_f32_32x32x32_bf16 v[64:79], v[208:211], v[32:39], v31
    v_exp_f32 v43, v43
    v_exp_f32 v44, v44
    v_exp_f32 v45, v45
    buffer_load_dwordx4 v13, s[28:31], s52 offen lds
    v_exp_f32 v46, v46
    ds_write_b128 v26, v[84:87] offset:8192
    v_exp_f32 v47, v47
    s_add_u32 m0, m0, 8192
    v_exp_f32 v48, v48
    v_exp_f32 v49, v49
    v_smfmac_f32_32x32x32_bf16 v[64:79], v[212:215], v[40:47], v31
    v_exp_f32 v50, v50
    s_xor_b32 s52, s85, 131072
    v_exp_f32 v51, v51
    v_exp_f32 v52, v52
    v_mfma_f32_32x32x16_bf16 v[32:47], v[176:179], v[116:119], v[96:111]
    v_exp_f32 v53, v53
    v_exp_f32 v54, v54
    v_exp_f32 v55, v55
    v_exp_f32 v56, v56
    v_exp_f32 v57, v57
    v_exp_f32 v58, v58
    v_smfmac_f32_32x32x32_bf16 v[64:79], v[216:219], v[48:55], v31
    v_exp_f32 v59, v59
    v_exp_f32 v60, v60
    v_exp_f32 v61, v61
    buffer_load_dwordx4 v13, s[28:31], s52 offen lds
    v_exp_f32 v62, v62
    ds_write_b32 v26, v88 offset:16384
    v_exp_f32 v63, v63
    s_add_u32 m0, m0, 8192
    v_exp_f32 v32, v32
    v_exp_f32 v33, v33
    v_smfmac_f32_32x32x32_bf16 v[64:79], v[220:223], v[56:63], v31
    v_exp_f32 v34, v34
    s_setprio 1
    s_xor_b32 s52, s85, 196608
    v_exp_f32 v35, v35
    v_exp_f32 v36, v36
    v_mfma_f32_32x32x16_bf16 v[48:63], v[180:183], v[116:119], v[96:111]
    v_exp_f32 v37, v37
    v_exp_f32 v38, v38
    v_exp_f32 v39, v39
    v_exp_f32 v40, v40
    v_exp_f32 v41, v41
    v_exp_f32 v42, v42
    v_smfmac_f32_32x32x32_bf16 v[64:79], v[224:227], v[32:39], v31
    v_exp_f32 v43, v43
    v_exp_f32 v44, v44
    v_exp_f32 v45, v45
    buffer_load_dwordx4 v13, s[28:31], s52 offen lds
    v_exp_f32 v46, v46
    v_exp_f32 v47, v47
    s_add_u32 m0, m0, 8192
    v_exp_f32 v48, v48
    s_setprio 0
    v_exp_f32 v49, v49
    v_smfmac_f32_32x32x32_bf16 v[64:79], v[228:231], v[40:47], v31
    v_exp_f32 v50, v50
    v_exp_f32 v51, v51
    v_exp_f32 v52, v52
    v_mfma_f32_32x32x16_bf16 v[32:47], v[184:187], v[116:119], v[96:111]
    v_exp_f32 v53, v53
    v_exp_f32 v54, v54
    v_exp_f32 v55, v55
    s_waitcnt lgkmcnt(0)
    s_setprio 3
    s_barrier
    v_exp_f32 v56, v56
    v_exp_f32 v57, v57
    v_exp_f32 v58, v58
    v_smfmac_f32_32x32x32_bf16 v[64:79], v[232:235], v[48:55], v31
    v_exp_f32 v59, v59
    v_exp_f32 v60, v60
    v_exp_f32 v61, v61
    ds_read_b32 v122, v25 offset:16388
    v_exp_f32 v62, v62
    v_exp_f32 v63, v63
    ds_read_b128 v[112:115], v25 offset:24576
    v_exp_f32 v32, v32
    v_exp_f32 v33, v33
    v_smfmac_f32_32x32x32_bf16 v[64:79], v[236:239], v[56:63], v31
    v_exp_f32 v34, v34
    v_exp_f32 v35, v35
    v_exp_f32 v36, v36
    s_waitcnt vmcnt(10)
    v_mfma_f32_32x32x16_bf16 v[48:63], v[188:191], v[116:119], v[96:111]
    v_exp_f32 v37, v37
    v_exp_f32 v38, v38
    v_exp_f32 v39, v39
    v_exp_f32 v40, v40
    ds_read_b128 v[80:83], v20 offset:0
    v_exp_f32 v41, v41
    v_exp_f32 v42, v42
    v_smfmac_f32_32x32x32_bf16 v[64:79], v[240:243], v[32:39], v31
    v_exp_f32 v43, v43
    v_exp_f32 v44, v44
    s_waitcnt lgkmcnt(2)
    v_exp_f32 v45, v45
    v_mfma_f32_32x32x8_bf16 v[96:111], v[124:125], v[122:123], 0
    v_exp_f32 v46, v46
    v_exp_f32 v47, v47
    ds_read_b128 v[84:87], v20 offset:8192
    v_exp_f32 v48, v48
    v_exp_f32 v49, v49
    v_smfmac_f32_32x32x32_bf16 v[64:79], v[244:247], v[40:47], v31
    v_exp_f32 v50, v50
    v_exp_f32 v51, v51
    s_waitcnt lgkmcnt(2)
    v_exp_f32 v52, v52
    s_waitcnt vmcnt(7)
    v_mfma_f32_32x32x16_bf16 v[32:47], v[160:163], v[112:115], v[96:111]
    v_exp_f32 v53, v53
    v_exp_f32 v54, v54
    v_exp_f32 v55, v55
    v_exp_f32 v56, v56
    ds_read_b32 v88, v20 offset:16384
    v_exp_f32 v57, v57
    v_exp_f32 v58, v58
    v_smfmac_f32_32x32x32_bf16 v[64:79], v[248:251], v[48:55], v31
    v_exp_f32 v59, v59
    v_exp_f32 v60, v60
    v_exp_f32 v61, v61
    v_exp_f32 v62, v62
    v_exp_f32 v63, v63
    v_exp_f32 v32, v32
    v_exp_f32 v33, v33
    v_smfmac_f32_32x32x32_bf16 v[64:79], v[252:255], v[56:63], v31
    v_exp_f32 v34, v34
    s_xor_b32 s52, s85, 262144
    v_exp_f32 v35, v35
    v_exp_f32 v36, v36
    v_mfma_f32_32x32x16_bf16 v[48:63], v[164:167], v[112:115], v[96:111]
    v_exp_f32 v37, v37
    v_exp_f32 v38, v38
    v_exp_f32 v39, v39
    v_exp_f32 v40, v40
    s_waitcnt lgkmcnt(0)
    v_exp_f32 v41, v41
    v_exp_f32 v42, v42
    v_smfmac_f32_32x32x32_bf16 v[80:95], v[192:195], v[32:39], v31
    v_exp_f32 v43, v43
    v_exp_f32 v44, v44
    v_exp_f32 v45, v45
    buffer_load_dwordx4 v13, s[28:31], s52 offen lds
    v_exp_f32 v46, v46
    v_exp_f32 v47, v47
    s_add_u32 m0, m0, 8192
    v_exp_f32 v48, v48
    v_exp_f32 v49, v49
    v_smfmac_f32_32x32x32_bf16 v[80:95], v[196:199], v[40:47], v31
    v_exp_f32 v50, v50
    v_exp_f32 v51, v51
    v_exp_f32 v52, v52
    v_mfma_f32_32x32x16_bf16 v[32:47], v[168:171], v[112:115], v[96:111]
    v_exp_f32 v53, v53
    v_exp_f32 v54, v54
    v_exp_f32 v55, v55
    s_setprio 2
    v_exp_f32 v56, v56
    buffer_load_dword v19, v18, s[32:35], 0 offen sc1
    v_exp_f32 v57, v57
    v_exp_f32 v58, v58
    v_smfmac_f32_32x32x32_bf16 v[80:95], v[200:203], v[48:55], v31
    v_exp_f32 v59, v59
    v_exp_f32 v60, v60
    v_exp_f32 v61, v61
    v_exp_f32 v62, v62
    ds_write_b128 v20, v[64:67] offset:0
    v_exp_f32 v63, v63
    v_exp_f32 v32, v32
    v_exp_f32 v33, v33
    v_smfmac_f32_32x32x32_bf16 v[80:95], v[204:207], v[56:63], v31
    v_exp_f32 v34, v34
    s_xor_b32 s52, s85, 327680
    v_exp_f32 v35, v35
    v_exp_f32 v36, v36
    v_mfma_f32_32x32x16_bf16 v[48:63], v[172:175], v[112:115], v[96:111]
    v_exp_f32 v37, v37
    v_exp_f32 v38, v38
    v_exp_f32 v39, v39
    v_exp_f32 v40, v40
    v_exp_f32 v41, v41
    v_exp_f32 v42, v42
    v_smfmac_f32_32x32x32_bf16 v[80:95], v[208:211], v[32:39], v31
    v_exp_f32 v43, v43
    v_exp_f32 v44, v44
    v_exp_f32 v45, v45
    buffer_load_dwordx4 v13, s[28:31], s52 offen lds
    v_exp_f32 v46, v46
    ds_write_b128 v20, v[68:71] offset:8192
    v_exp_f32 v47, v47
    s_add_u32 m0, m0, 8192
    v_exp_f32 v48, v48
    v_exp_f32 v49, v49
    v_smfmac_f32_32x32x32_bf16 v[80:95], v[212:215], v[40:47], v31
    v_exp_f32 v50, v50
    s_xor_b32 s52, s85, 393216
    v_exp_f32 v51, v51
    v_exp_f32 v52, v52
    v_mfma_f32_32x32x16_bf16 v[32:47], v[176:179], v[112:115], v[96:111]
    v_exp_f32 v53, v53
    v_exp_f32 v54, v54
    v_exp_f32 v55, v55
    v_exp_f32 v56, v56
    v_exp_f32 v57, v57
    v_exp_f32 v58, v58
    v_smfmac_f32_32x32x32_bf16 v[80:95], v[216:219], v[48:55], v31
    v_exp_f32 v59, v59
    v_exp_f32 v60, v60
    v_exp_f32 v61, v61
    buffer_load_dwordx4 v13, s[28:31], s52 offen lds
    v_exp_f32 v62, v62
    ds_write_b32 v20, v72 offset:16384
    v_exp_f32 v63, v63
    s_add_u32 m0, m0, 8192
    v_exp_f32 v32, v32
    v_exp_f32 v33, v33
    v_smfmac_f32_32x32x32_bf16 v[80:95], v[220:223], v[56:63], v31
    v_exp_f32 v34, v34
    s_setprio 1
    s_xor_b32 s52, s85, 458752
    v_exp_f32 v35, v35
    v_exp_f32 v36, v36
    v_mfma_f32_32x32x16_bf16 v[48:63], v[180:183], v[112:115], v[96:111]
    v_exp_f32 v37, v37
    v_exp_f32 v38, v38
    v_exp_f32 v39, v39
    v_exp_f32 v40, v40
    v_exp_f32 v41, v41
    v_exp_f32 v42, v42
    v_smfmac_f32_32x32x32_bf16 v[80:95], v[224:227], v[32:39], v31
    v_exp_f32 v43, v43
    v_exp_f32 v44, v44
    v_exp_f32 v45, v45
    buffer_load_dwordx4 v13, s[28:31], s52 offen lds
    v_exp_f32 v46, v46
    v_exp_f32 v47, v47
    s_add_u32 m0, m0, 8192
    v_exp_f32 v48, v48
    s_setprio 0
    v_exp_f32 v49, v49
    v_smfmac_f32_32x32x32_bf16 v[80:95], v[228:231], v[40:47], v31
    v_exp_f32 v50, v50
    v_exp_f32 v51, v51
    v_exp_f32 v52, v52
    v_mfma_f32_32x32x16_bf16 v[32:47], v[184:187], v[112:115], v[96:111]
    v_exp_f32 v53, v53
    v_exp_f32 v54, v54
    v_exp_f32 v55, v55
    s_waitcnt lgkmcnt(0)
    s_setprio 3
    s_barrier
    v_exp_f32 v56, v56
    v_exp_f32 v57, v57
    v_exp_f32 v58, v58
    v_smfmac_f32_32x32x32_bf16 v[80:95], v[232:235], v[48:55], v31
    v_exp_f32 v59, v59
    v_exp_f32 v60, v60
    v_exp_f32 v61, v61
    ds_read_b32 v120, v26 offset:16388
    v_exp_f32 v62, v62
    v_exp_f32 v63, v63
    ds_read_b128 v[116:119], v26 offset:24576
    v_exp_f32 v32, v32
    v_exp_f32 v33, v33
    v_smfmac_f32_32x32x32_bf16 v[80:95], v[236:239], v[56:63], v31
    v_exp_f32 v34, v34
    v_exp_f32 v35, v35
    v_exp_f32 v36, v36
    v_mfma_f32_32x32x16_bf16 v[48:63], v[188:191], v[112:115], v[96:111]
    v_exp_f32 v37, v37
    v_exp_f32 v38, v38
    v_exp_f32 v39, v39
    v_exp_f32 v40, v40
    ds_read_b128 v[64:67], v22 offset:0
    v_exp_f32 v41, v41
    v_exp_f32 v42, v42
    v_smfmac_f32_32x32x32_bf16 v[80:95], v[240:243], v[32:39], v31
    v_exp_f32 v43, v43
    v_exp_f32 v44, v44
    s_waitcnt lgkmcnt(2)
    v_exp_f32 v45, v45
    v_mfma_f32_32x32x8_bf16 v[96:111], v[124:125], v[120:121], 0
    v_exp_f32 v46, v46
    v_exp_f32 v47, v47
    ds_read_b128 v[68:71], v22 offset:8192
    v_exp_f32 v48, v48
    v_exp_f32 v49, v49
    v_smfmac_f32_32x32x32_bf16 v[80:95], v[244:247], v[40:47], v31
    v_exp_f32 v50, v50
    v_exp_f32 v51, v51
    s_waitcnt lgkmcnt(2)
    v_exp_f32 v52, v52
    v_mfma_f32_32x32x16_bf16 v[32:47], v[160:163], v[116:119], v[96:111]
    v_exp_f32 v53, v53
    v_exp_f32 v54, v54
    v_exp_f32 v55, v55
    v_exp_f32 v56, v56
    ds_read_b32 v72, v22 offset:16384
    v_exp_f32 v57, v57
    v_exp_f32 v58, v58
    v_smfmac_f32_32x32x32_bf16 v[80:95], v[248:251], v[48:55], v31
    v_exp_f32 v59, v59
    v_exp_f32 v60, v60
    v_exp_f32 v61, v61
    v_exp_f32 v62, v62
    v_exp_f32 v63, v63
    v_exp_f32 v32, v32
    v_exp_f32 v33, v33
    v_smfmac_f32_32x32x32_bf16 v[80:95], v[252:255], v[56:63], v31
    v_exp_f32 v34, v34
    v_exp_f32 v35, v35
    s_waitcnt vmcnt(3)
    v_exp_f32 v36, v36
    v_mfma_f32_32x32x16_bf16 v[48:63], v[164:167], v[116:119], v[96:111]
    v_exp_f32 v37, v37
    v_cmp_ne_u32 vcc, s49, v19
    v_exp_f32 v38, v38
    v_exp_f32 v39, v39
    s_cbranch_vccnz L_ob_late
L_ob_ok:
    v_exp_f32 v40, v40
    s_waitcnt lgkmcnt(0)
    v_exp_f32 v41, v41
    v_exp_f32 v42, v42
    v_smfmac_f32_32x32x32_bf16 v[64:79], v[192:195], v[32:39], v31
    v_exp_f32 v43, v43
    v_exp_f32 v44, v44
    v_exp_f32 v45, v45
    buffer_load_dwordx4 v[128:131], v9, s[32:35], s86 offen sc1
    v_exp_f32 v46, v46
    v_exp_f32 v47, v47
    v_exp_f32 v48, v48
    v_exp_f32 v49, v49
    v_smfmac_f32_32x32x32_bf16 v[64:79], v[196:199], v[40:47], v31
    v_exp_f32 v50, v50
    v_exp_f32 v51, v51
    v_exp_f32 v52, v52
    v_mfma_f32_32x32x16_bf16 v[32:47], v[168:171], v[116:119], v[96:111]
    v_exp_f32 v53, v53
    v_exp_f32 v54, v54
    v_exp_f32 v55, v55
    s_setprio 2
    v_exp_f32 v56, v56
    buffer_load_dwordx4 v[132:135], v9, s[32:35], s87 offen sc1
    v_exp_f32 v57, v57
    v_exp_f32 v58, v58
    v_smfmac_f32_32x32x32_bf16 v[64:79], v[200:203], v[48:55], v31
    v_exp_f32 v59, v59
    v_exp_f32 v60, v60
    v_exp_f32 v61, v61
    v_exp_f32 v62, v62
    ds_write_b128 v22, v[80:83] offset:0
    v_exp_f32 v63, v63
    v_exp_f32 v32, v32
    v_exp_f32 v33, v33
    v_smfmac_f32_32x32x32_bf16 v[64:79], v[204:207], v[56:63], v31
    v_exp_f32 v34, v34
    v_exp_f32 v35, v35
    v_exp_f32 v36, v36
    v_mfma_f32_32x32x16_bf16 v[48:63], v[172:175], v[116:119], v[96:111]
    v_exp_f32 v37, v37
    v_exp_f32 v38, v38
    v_exp_f32 v39, v39
    v_exp_f32 v40, v40
    buffer_load_dwordx4 v[136:139], v9, s[32:35], s88 offen sc1
    v_exp_f32 v41, v41
    v_exp_f32 v42, v42
    v_smfmac_f32_32x32x32_bf16 v[64:79], v[208:211], v[32:39], v31
    v_exp_f32 v43, v43
    v_exp_f32 v44, v44
    v_exp_f32 v45, v45
    v_exp_f32 v46, v46
    ds_write_b128 v22, v[84:87] offset:8192
    v_exp_f32 v47, v47
    v_exp_f32 v48, v48
    v_exp_f32 v49, v49
    v_smfmac_f32_32x32x32_bf16 v[64:79], v[212:215], v[40:47], v31
    v_exp_f32 v50, v50
    v_exp_f32 v51, v51
    v_exp_f32 v52, v52
    v_mfma_f32_32x32x16_bf16 v[32:47], v[176:179], v[116:119], v[96:111]
    v_exp_f32 v53, v53
    v_exp_f32 v54, v54
    v_exp_f32 v55, v55
    v_exp_f32 v56, v56
    buffer_load_dwordx4 v[140:143], v9, s[32:35], s89 offen sc1
    v_exp_f32 v57, v57
    v_exp_f32 v58, v58
    v_smfmac_f32_32x32x32_bf16 v[64:79], v[216:219], v[48:55], v31
    v_exp_f32 v59, v59
    v_exp_f32 v60, v60
    v_exp_f32 v61, v61
    v_exp_f32 v62, v62
    ds_write_b32 v22, v88 offset:16384
    v_exp_f32 v63, v63
    v_exp_f32 v32, v32
    v_exp_f32 v33, v33
    v_smfmac_f32_32x32x32_bf16 v[64:79], v[220:223], v[56:63], v31
    v_exp_f32 v34, v34
    s_setprio 1
    v_exp_f32 v35, v35
    v_exp_f32 v36, v36
    v_mfma_f32_32x32x16_bf16 v[48:63], v[180:183], v[116:119], v[96:111]
    v_exp_f32 v37, v37
    v_exp_f32 v38, v38
    v_exp_f32 v39, v39
    v_exp_f32 v40, v40
    buffer_load_dwordx4 v[144:147], v9, s[32:35], s90 offen sc1
    v_exp_f32 v41, v41
    v_exp_f32 v42, v42
    v_smfmac_f32_32x32x32_bf16 v[64:79], v[224:227], v[32:39], v31
    v_exp_f32 v43, v43
    v_exp_f32 v44, v44
    v_exp_f32 v45, v45
    v_exp_f32 v46, v46
    buffer_load_dwordx4 v[148:151], v9, s[32:35], s91 offen sc1
    v_exp_f32 v47, v47
    v_exp_f32 v48, v48
    s_setprio 0
    v_exp_f32 v49, v49
    v_smfmac_f32_32x32x32_bf16 v[64:79], v[228:231], v[40:47], v31
    v_exp_f32 v50, v50
    v_exp_f32 v51, v51
    v_exp_f32 v52, v52
    v_mfma_f32_32x32x16_bf16 v[32:47], v[184:187], v[116:119], v[96:111]
    v_exp_f32 v53, v53
    v_exp_f32 v54, v54
    v_exp_f32 v55, v55
    s_waitcnt vmcnt(6) lgkmcnt(0)
    s_setprio 3
    s_barrier
    v_exp_f32 v56, v56
    v_exp_f32 v57, v57
    v_exp_f32 v58, v58
    v_smfmac_f32_32x32x32_bf16 v[64:79], v[232:235], v[48:55], v31
    v_exp_f32 v59, v59
    v_exp_f32 v60, v60
    v_exp_f32 v61, v61
    ds_read_b32 v122, v27 offset:16388
    v_exp_f32 v62, v62
    v_exp_f32 v63, v63
    ds_read_b128 v[112:115], v27 offset:24576
    v_exp_f32 v32, v32
    v_exp_f32 v33, v33
    v_smfmac_f32_32x32x32_bf16 v[64:79], v[236:239], v[56:63], v31
    v_exp_f32 v34, v34
    v_exp_f32 v35, v35
    buffer_load_dwordx4 v[152:155], v9, s[32:35], s92 offen sc1
    v_exp_f32 v36, v36
    v_mfma_f32_32x32x16_bf16 v[48:63], v[188:191], v[116:119], v[96:111]
    v_exp_f32 v37, v37
    v_exp_f32 v38, v38
    v_exp_f32 v39, v39
    v_exp_f32 v40, v40
    ds_read_b128 v[80:83], v20 offset:0
    v_exp_f32 v41, v41
    v_exp_f32 v42, v42
    v_smfmac_f32_32x32x32_bf16 v[64:79], v[240:243], v[32:39], v31
    v_exp_f32 v43, v43
    v_exp_f32 v44, v44
    s_waitcnt lgkmcnt(2)
    v_exp_f32 v45, v45
    v_mfma_f32_32x32x8_bf16 v[96:111], v[124:125], v[122:123], 0
    v_exp_f32 v46, v46
    v_exp_f32 v47, v47
    ds_read_b128 v[84:87], v20 offset:8192
    v_exp_f32 v48, v48
    v_exp_f32 v49, v49
    v_smfmac_f32_32x32x32_bf16 v[64:79], v[244:247], v[40:47], v31
    buffer_load_dwordx4 v[116:119], v14, s[32:35], s54 offen sc1
    v_exp_f32 v50, v50
    v_exp_f32 v51, v51
    s_waitcnt lgkmcnt(2)
    v_exp_f32 v52, v52
    v_mfma_f32_32x32x16_bf16 v[32:47], v[160:163], v[112:115], v[96:111]
    v_exp_f32 v53, v53
    v_mov_b32 v28, v8
    v_exp_f32 v54, v54
    v_exp_f32 v55, v55
    v_xor_b32 v29, 32, v8
    v_exp_f32 v56, v56
    s_setprio 2
    ds_read_b32 v88, v20 offset:16384
    v_exp_f32 v57, v57
    v_xor_b32 v30, 0x18000, v8
    v_exp_f32 v58, v58
    v_smfmac_f32_32x32x32_bf16 v[64:79], v[248:251], v[48:55], v31
    v_exp_f32 v59, v59
    v_xor_b32 v17, 0x18020, v8
    v_exp_f32 v60, v60
    v_exp_f32 v61, v61
    buffer_load_dwordx4 v[156:159], v9, s[32:35], s93 offen sc1
    v_xor_b32 v11, 0x4000, v9
    v_exp_f32 v62, v62
    v_exp_f32 v63, v63
    v_exp_f32 v32, v32
    v_exp_f32 v33, v33
    v_smfmac_f32_32x32x32_bf16 v[64:79], v[252:255], v[56:63], v31
    v_exp_f32 v34, v34
    v_exp_f32 v35, v35
    buffer_load_dword v124, v12, s[32:35], s55 offen sc1
    v_exp_f32 v36, v36
    v_mfma_f32_32x32x16_bf16 v[48:63], v[164:167], v[112:115], v[96:111]
    s_setprio 1
    v_exp_f32 v37, v37
    v_exp_f32 v38, v38
    ds_read_b64_tr_b16 v[164:165], v28 offset:0
    v_exp_f32 v39, v39
    v_exp_f32 v40, v40
    s_waitcnt lgkmcnt(1)
    v_exp_f32 v41, v41
    v_exp_f32 v42, v42
    v_smfmac_f32_32x32x32_bf16 v[80:95], v[192:195], v[32:39], v31
    v_exp_f32 v43, v43
    v_exp_f32 v44, v44
    buffer_load_dwordx4 v[160:163], v11, s[32:35], s86 offen sc1
    v_exp_f32 v45, v45
    v_exp_f32 v46, v46
    v_exp_f32 v47, v47
    v_exp_f32 v48, v48
    ds_write_b128 v20, v[64:67] offset:0
    v_exp_f32 v49, v49
    v_smfmac_f32_32x32x32_bf16 v[80:95], v[196:199], v[40:47], v31
    ds_write_b128 v20, v[68:71] offset:8192
    v_exp_f32 v50, v50
    s_setprio 0
    v_exp_f32 v51, v51
    ds_write_b32 v20, v72 offset:16384
    v_exp_f32 v52, v52
    v_mfma_f32_32x32x16_bf16 v[32:47], v[168:171], v[112:115], v[96:111]
    v_exp_f32 v53, v53
    v_exp_f32 v54, v54
    ds_read_b64_tr_b16 v[166:167], v28 offset:512
    v_exp_f32 v55, v55
    v_exp_f32 v56, v56
    v_exp_f32 v57, v57
    s_waitcnt lgkmcnt(1)
    s_setprio 3
    s_barrier
    v_exp_f32 v58, v58
    v_smfmac_f32_32x32x32_bf16 v[80:95], v[200:203], v[48:55], v31
    v_exp_f32 v59, v59
    v_exp_f32 v60, v60
    buffer_load_dwordx4 v[168:171], v11, s[32:35], s87 offen sc1
    v_exp_f32 v61, v61
    v_exp_f32 v62, v62
    v_exp_f32 v63, v63
    v_exp_f32 v32, v32
    v_exp_f32 v33, v33
    v_smfmac_f32_32x32x32_bf16 v[80:95], v[204:207], v[56:63], v31
    v_exp_f32 v34, v34
    v_exp_f32 v35, v35
    v_exp_f32 v36, v36
    v_mfma_f32_32x32x16_bf16 v[48:63], v[172:175], v[112:115], v[96:111]
    v_exp_f32 v37, v37
    v_exp_f32 v38, v38
    ds_read_b64_tr_b16 v[196:197], v29 offset:0
    v_exp_f32 v39, v39
    v_exp_f32 v40, v40
    v_exp_f32 v41, v41
    v_exp_f32 v42, v42
    v_smfmac_f32_32x32x32_bf16 v[80:95], v[208:211], v[32:39], v31
    v_exp_f32 v43, v43
    v_exp_f32 v44, v44
    buffer_load_dwordx4 v[192:195], v11, s[32:35], s88 offen sc1
    v_exp_f32 v45, v45
    v_exp_f32 v46, v46
    v_exp_f32 v47, v47
    v_exp_f32 v48, v48
    v_exp_f32 v49, v49
    v_smfmac_f32_32x32x32_bf16 v[80:95], v[212:215], v[40:47], v31
    v_exp_f32 v50, v50
    v_exp_f32 v51, v51
    v_exp_f32 v52, v52
    v_mfma_f32_32x32x16_bf16 v[32:47], v[176:179], v[112:115], v[96:111]
    v_exp_f32 v53, v53
    v_exp_f32 v54, v54
    ds_read_b64_tr_b16 v[198:199], v29 offset:512
    v_exp_f32 v55, v55
    v_exp_f32 v56, v56
    v_exp_f32 v57, v57
    v_exp_f32 v58, v58
    v_smfmac_f32_32x32x32_bf16 v[80:95], v[216:219], v[48:55], v31
    v_exp_f32 v59, v59
    v_exp_f32 v60, v60
    buffer_load_dwordx4 v[172:175], v11, s[32:35], s89 offen sc1
    v_exp_f32 v61, v61
    v_exp_f32 v62, v62
    v_exp_f32 v63, v63
    v_exp_f32 v32, v32
    v_exp_f32 v33, v33
    v_smfmac_f32_32x32x32_bf16 v[80:95], v[220:223], v[56:63], v31
    v_exp_f32 v34, v34
    v_exp_f32 v35, v35
    v_exp_f32 v36, v36
    v_mfma_f32_32x32x16_bf16 v[48:63], v[180:183], v[112:115], v[96:111]
    v_exp_f32 v37, v37
    v_exp_f32 v38, v38
    ds_read_b64_tr_b16 v[204:205], v28 offset:4096
    v_exp_f32 v39, v39
    v_exp_f32 v40, v40
    v_exp_f32 v41, v41
    v_exp_f32 v42, v42
    v_smfmac_f32_32x32x32_bf16 v[80:95], v[224:227], v[32:39], v31
    v_exp_f32 v43, v43
    v_exp_f32 v44, v44
    buffer_load_dwordx4 v[200:203], v11, s[32:35], s90 offen sc1
    v_exp_f32 v45, v45
    v_exp_f32 v46, v46
    v_exp_f32 v47, v47
    v_exp_f32 v48, v48
    v_exp_f32 v49, v49
    v_smfmac_f32_32x32x32_bf16 v[80:95], v[228:231], v[40:47], v31
    v_exp_f32 v50, v50
    v_exp_f32 v51, v51
    v_exp_f32 v52, v52
    v_mfma_f32_32x32x16_bf16 v[32:47], v[184:187], v[112:115], v[96:111]
    v_exp_f32 v53, v53
    v_exp_f32 v54, v54
    ds_read_b64_tr_b16 v[206:207], v28 offset:4608
    v_exp_f32 v55, v55
    v_exp_f32 v56, v56
    v_exp_f32 v57, v57
    v_exp_f32 v58, v58
    v_smfmac_f32_32x32x32_bf16 v[80:95], v[232:235], v[48:55], v31
    ds_read_b128 v[64:67], v21 offset:0
    v_exp_f32 v59, v59
    v_exp_f32 v60, v60
    buffer_load_dwordx4 v[176:179], v11, s[32:35], s91 offen sc1
    v_exp_f32 v61, v61
    v_exp_f32 v62, v62
    v_exp_f32 v63, v63
    v_exp_f32 v32, v32
    v_exp_f32 v33, v33
    v_smfmac_f32_32x32x32_bf16 v[80:95], v[236:239], v[56:63], v31
    v_exp_f32 v34, v34
    ds_read_b128 v[68:71], v21 offset:8192
    v_exp_f32 v35, v35
    v_exp_f32 v36, v36
    v_mfma_f32_32x32x16_bf16 v[48:63], v[188:191], v[112:115], v[96:111]
    v_exp_f32 v37, v37
    v_exp_f32 v38, v38
    ds_read_b64_tr_b16 v[212:213], v29 offset:4096
    v_exp_f32 v39, v39
    v_exp_f32 v40, v40
    v_exp_f32 v41, v41
    v_exp_f32 v42, v42
    v_smfmac_f32_32x32x32_bf16 v[80:95], v[240:243], v[32:39], v31
    ds_read_b32 v72, v21 offset:16384
    v_exp_f32 v43, v43
    v_exp_f32 v44, v44
    buffer_load_dwordx4 v[208:211], v11, s[32:35], s92 offen sc1
    v_exp_f32 v45, v45
    v_exp_f32 v46, v46
    v_exp_f32 v47, v47
    v_exp_f32 v48, v48
    v_exp_f32 v49, v49
    v_smfmac_f32_32x32x32_bf16 v[80:95], v[244:247], v[40:47], v31
    v_exp_f32 v50, v50
    v_exp_f32 v51, v51
    v_exp_f32 v52, v52
    v_exp_f32 v53, v53
    v_exp_f32 v54, v54
    ds_read_b64_tr_b16 v[214:215], v29 offset:4608
    v_exp_f32 v55, v55
    v_exp_f32 v56, v56
    v_exp_f32 v57, v57
    v_exp_f32 v58, v58
    v_smfmac_f32_32x32x32_bf16 v[80:95], v[248:251], v[48:55], v31
    v_exp_f32 v59, v59
    v_exp_f32 v60, v60
    buffer_load_dwordx4 v[180:183], v11, s[32:35], s93 offen sc1
    v_exp_f32 v61, v61
    v_exp_f32 v62, v62
    v_exp_f32 v63, v63
    s_nop 1
    v_smfmac_f32_32x32x32_bf16 v[80:95], v[252:255], v[56:63], v31
    s_mov_b32 s60, 0x21800000
    s_mov_b32 s61, 0x7b800000
    s_waitcnt vmcnt(8) lgkmcnt(1)
    v_add_f32 v72, v72, v124
    v_lshlrev_b32 v2, 16, v116
    v_and_b32 v3, 0xffff0000, v116
    v_lshlrev_b32 v4, 16, v117
    v_and_b32 v5, 0xffff0000, v117
    v_lshlrev_b32 v120, 16, v118
    v_and_b32 v121, 0xffff0000, v118
    v_lshlrev_b32 v122, 16, v119
    v_and_b32 v123, 0xffff0000, v119
    v_pk_add_f32 v[64:65], v[64:65], v[2:3]
    v_pk_add_f32 v[66:67], v[66:67], v[4:5]
    v_pk_add_f32 v[68:69], v[68:69], v[120:121]
    v_pk_add_f32 v[70:71], v[70:71], v[122:123]
    v_add_f32 v72, v72, v88
    v_pk_add_f32 v[64:65], v[64:65], v[80:81]
    v_pk_add_f32 v[66:67], v[66:67], v[82:83]
    v_pk_add_f32 v[68:69], v[68:69], v[84:85]
    v_pk_add_f32 v[70:71], v[70:71], v[86:87]
    v_rcp_f32 v6, v72
    v_pk_mul_f32 v[2:3], v[64:65], v[64:65]
    v_pk_mul_f32 v[4:5], v[66:67], v[66:67]
    v_pk_fma_f32 v[2:3], v[68:69], v[68:69], v[2:3]
    v_pk_fma_f32 v[4:5], v[70:71], v[70:71], v[4:5]
    v_cmp_lt_f32 s[52:53], s60, v72
    v_pk_add_f32 v[2:3], v[2:3], v[4:5]
    v_fma_f32 v2, v72, v72, v2
    v_add_f32 v2, v2, v3
    v_cmp_gt_f32 vcc, s61, v2
    s_nop 0
    s_and_b64 vcc, vcc, s[52:53]
    s_cmp_eq_u64 vcc, -1
    s_cbranch_scc0 L_fallback
L_att_ok:
    v_pk_mul_f32 v[64:65], v[64:65], v[6:7] op_sel_hi:[1,0]
    v_pk_mul_f32 v[66:67], v[66:67], v[6:7] op_sel_hi:[1,0]
    v_pk_mul_f32 v[68:69], v[68:69], v[6:7] op_sel_hi:[1,0]
    v_pk_mul_f32 v[70:71], v[70:71], v[6:7] op_sel_hi:[1,0]
    v_cvt_pk_bf16_f32 v112, v64, v65
    v_cvt_pk_bf16_f32 v113, v66, v67
    v_cvt_pk_bf16_f32 v114, v68, v69
    v_cvt_pk_bf16_f32 v115, v70, v71
    v_min_u32 v112, -2, v112
    v_min_u32 v114, -2, v114
    v_min_u32 v113, -2, v113
    v_min_u32 v115, -2, v115
    v_permlane32_swap_b32 v112, v114
    s_nop 0
    v_permlane32_swap_b32 v113, v115
    buffer_store_dwordx4 v[112:115], v14, s[32:35], s71 offen sc1
    s_setprio 0
    v_subrev_u32 v9, 2097152, v9
    v_mov_b32 v2, 0
    v_mov_b32 v3, 0
    s_waitcnt vmcnt(9) lgkmcnt(0)
    v_mfma_f32_16x16x32_bf16 v[96:99], v[164:167], v[128:131], 0
    ds_read_b64_tr_b16 v[216:217], v28 offset:8192
    ds_read_b64_tr_b16 v[218:219], v28 offset:8704
    ds_read_b64_tr_b16 v[220:221], v29 offset:8192
    ds_read_b64_tr_b16 v[222:223], v29 offset:8704
    v_mfma_f32_16x16x32_bf16 v[100:103], v[196:199], v[128:131], 0
    ds_read_b64_tr_b16 v[184:185], v28 offset:12288
    ds_read_b64_tr_b16 v[186:187], v28 offset:12800
    ds_read_b64_tr_b16 v[224:225], v29 offset:12288
    ds_read_b64_tr_b16 v[226:227], v29 offset:12800
    v_mfma_f32_16x16x32_bf16 v[96:99], v[204:207], v[132:135], v[96:99]
    ds_read_b64_tr_b16 v[228:229], v28 offset:16384
    ds_read_b64_tr_b16 v[230:231], v28 offset:16896
    ds_read_b64_tr_b16 v[188:189], v29 offset:16384
    ds_read_b64_tr_b16 v[190:191], v29 offset:16896
    v_mfma_f32_16x16x32_bf16 v[100:103], v[212:215], v[132:135], v[100:103]
    ds_read_b64_tr_b16 v[232:233], v28 offset:20480
    ds_read_b64_tr_b16 v[234:235], v28 offset:20992
    ds_read_b64_tr_b16 v[236:237], v29 offset:20480
    ds_read_b64_tr_b16 v[238:239], v29 offset:20992
    s_waitcnt vmcnt(9) lgkmcnt(8)
    v_mfma_f32_16x16x32_bf16 v[96:99], v[216:219], v[136:139], v[96:99]
    ds_read_b64_tr_b16 v[240:241], v28 offset:24576
    ds_read_b64_tr_b16 v[242:243], v28 offset:25088
    ds_read_b64_tr_b16 v[244:245], v29 offset:24576
    ds_read_b64_tr_b16 v[246:247], v29 offset:25088
    v_mfma_f32_16x16x32_bf16 v[100:103], v[220:223], v[136:139], v[100:103]
    ds_read_b64_tr_b16 v[248:249], v28 offset:28672
    ds_read_b64_tr_b16 v[250:251], v28 offset:29184
    ds_read_b64_tr_b16 v[252:253], v29 offset:28672
    ds_read_b64_tr_b16 v[254:255], v29 offset:29184
    v_mfma_f32_16x16x32_bf16 v[96:99], v[184:187], v[140:143], v[96:99]
    ds_read_b64_tr_b16 v[32:33], v30 offset:0
    ds_read_b64_tr_b16 v[34:35], v30 offset:512
    ds_read_b64_tr_b16 v[36:37], v17 offset:0
    ds_read_b64_tr_b16 v[38:39], v17 offset:512
    v_mfma_f32_16x16x32_bf16 v[100:103], v[224:227], v[140:143], v[100:103]
    ds_read_b64_tr_b16 v[40:41], v30 offset:4096
    ds_read_b64_tr_b16 v[42:43], v30 offset:4608
    ds_read_b64_tr_b16 v[44:45], v17 offset:4096
    ds_read_b64_tr_b16 v[46:47], v17 offset:4608
    s_waitcnt vmcnt(9) lgkmcnt(15)
    v_mfma_f32_16x16x32_bf16 v[96:99], v[228:231], v[144:147], v[96:99]
    ds_read_b64_tr_b16 v[48:49], v30 offset:8192
    ds_read_b64_tr_b16 v[50:51], v30 offset:8704
    ds_read_b64_tr_b16 v[52:53], v17 offset:8192
    ds_read_b64_tr_b16 v[54:55], v17 offset:8704
    v_mfma_f32_16x16x32_bf16 v[100:103], v[188:191], v[144:147], v[100:103]
    ds_read_b64_tr_b16 v[56:57], v30 offset:12288
    ds_read_b64_tr_b16 v[58:59], v30 offset:12800
    ds_read_b64_tr_b16 v[60:61], v17 offset:12288
    ds_read_b64_tr_b16 v[62:63], v17 offset:12800
    v_mfma_f32_32x32x8_bf16 v[112:127], v[2:3], v[2:3], 0
    v_mfma_f32_16x16x32_bf16 v[96:99], v[232:235], v[148:151], v[96:99]
    ds_read_b64_tr_b16 v[104:105], v30 offset:16384
    ds_read_b64_tr_b16 v[106:107], v30 offset:16896
    ds_read_b64_tr_b16 v[108:109], v17 offset:16384
    ds_read_b64_tr_b16 v[110:111], v17 offset:16896
    v_mfma_f32_16x16x32_bf16 v[100:103], v[236:239], v[148:151], v[100:103]
    ds_read_b64_tr_b16 v[164:165], v30 offset:20480
    ds_read_b64_tr_b16 v[166:167], v30 offset:20992
    ds_read_b64_tr_b16 v[196:197], v17 offset:20480
    ds_read_b64_tr_b16 v[198:199], v17 offset:20992
    s_waitcnt vmcnt(9) lgkmcnt(15)
    v_mfma_f32_16x16x32_bf16 v[96:99], v[240:243], v[152:155], v[96:99]
    ds_read_b64_tr_b16 v[128:129], v30 offset:24576
    ds_read_b64_tr_b16 v[130:131], v30 offset:25088
    ds_read_b64_tr_b16 v[204:205], v17 offset:24576
    ds_read_b64_tr_b16 v[206:207], v17 offset:25088
    v_mfma_f32_16x16x32_bf16 v[100:103], v[244:247], v[152:155], v[100:103]
    ds_read_b64_tr_b16 v[212:213], v30 offset:28672
    ds_read_b64_tr_b16 v[214:215], v30 offset:29184
    ds_read_b64_tr_b16 v[132:133], v17 offset:28672
    ds_read_b64_tr_b16 v[134:135], v17 offset:29184
    v_mfma_f32_16x16x32_bf16 v[96:99], v[248:251], v[156:159], v[96:99]
    v_add_u32 v28, 65536, v8
    v_xor_b32 v29, 32, v28
    v_xor_b32 v30, 64, v28
    v_xor_b32 v17, 96, v28
    ds_read_b64_tr_b16 v[216:217], v28 offset:0
    ds_read_b64_tr_b16 v[218:219], v28 offset:512
    ds_read_b64_tr_b16 v[220:221], v29 offset:0
    ds_read_b64_tr_b16 v[222:223], v29 offset:512
    v_mfma_f32_16x16x32_bf16 v[100:103], v[252:255], v[156:159], v[100:103]
    ds_read_b64_tr_b16 v[136:137], v30 offset:0
    ds_read_b64_tr_b16 v[138:139], v30 offset:512
    ds_read_b64_tr_b16 v[184:185], v17 offset:0
    ds_read_b64_tr_b16 v[186:187], v17 offset:512
    s_waitcnt vmcnt(8) lgkmcnt(15)
    v_mfma_f32_16x16x32_bf16 v[96:99], v[32:35], v[160:163], v[96:99]
    ds_read_b64_tr_b16 v[224:225], v28 offset:4096
    ds_read_b64_tr_b16 v[226:227], v28 offset:4608
    ds_read_b64_tr_b16 v[140:141], v29 offset:4096
    ds_read_b64_tr_b16 v[142:143], v29 offset:4608
    v_mfma_f32_16x16x32_bf16 v[100:103], v[36:39], v[160:163], v[100:103]
    ds_read_b64_tr_b16 v[228:229], v30 offset:4096
    ds_read_b64_tr_b16 v[230:231], v30 offset:4608
    ds_read_b64_tr_b16 v[188:189], v17 offset:4096
    ds_read_b64_tr_b16 v[190:191], v17 offset:4608
    s_waitcnt vmcnt(7) lgkmcnt(15)
    v_mfma_f32_16x16x32_bf16 v[96:99], v[40:43], v[168:171], v[96:99]
    ds_read_b64_tr_b16 v[144:145], v28 offset:8192
    ds_read_b64_tr_b16 v[146:147], v28 offset:8704
    ds_read_b64_tr_b16 v[232:233], v29 offset:8192
    ds_read_b64_tr_b16 v[234:235], v29 offset:8704
    v_mfma_f32_16x16x32_bf16 v[100:103], v[44:47], v[168:171], v[100:103]
    ds_read_b64_tr_b16 v[236:237], v30 offset:8192
    ds_read_b64_tr_b16 v[238:239], v30 offset:8704
    ds_read_b64_tr_b16 v[148:149], v17 offset:8192
    ds_read_b64_tr_b16 v[150:151], v17 offset:8704
    s_waitcnt vmcnt(6) lgkmcnt(15)
    v_mfma_f32_16x16x32_bf16 v[96:99], v[48:51], v[192:195], v[96:99]
    ds_read_b64_tr_b16 v[240:241], v28 offset:12288
    ds_read_b64_tr_b16 v[242:243], v28 offset:12800
    ds_read_b64_tr_b16 v[244:245], v29 offset:12288
    ds_read_b64_tr_b16 v[246:247], v29 offset:12800
    v_mfma_f32_16x16x32_bf16 v[100:103], v[52:55], v[192:195], v[100:103]
    ds_read_b64_tr_b16 v[152:153], v30 offset:12288
    ds_read_b64_tr_b16 v[154:155], v30 offset:12800
    ds_read_b64_tr_b16 v[248:249], v17 offset:12288
    ds_read_b64_tr_b16 v[250:251], v17 offset:12800
    s_waitcnt vmcnt(5) lgkmcnt(15)
    v_mfma_f32_16x16x32_bf16 v[96:99], v[56:59], v[172:175], v[96:99]
    ds_read_b64_tr_b16 v[252:253], v28 offset:16384
    ds_read_b64_tr_b16 v[254:255], v28 offset:16896
    ds_read_b64_tr_b16 v[156:157], v29 offset:16384
    ds_read_b64_tr_b16 v[158:159], v29 offset:16896
    v_mfma_f32_16x16x32_bf16 v[100:103], v[60:63], v[172:175], v[100:103]
    ds_read_b64_tr_b16 v[32:33], v30 offset:16384
    ds_read_b64_tr_b16 v[34:35], v30 offset:16896
    ds_read_b64_tr_b16 v[36:37], v17 offset:16384
    ds_read_b64_tr_b16 v[38:39], v17 offset:16896
    s_waitcnt vmcnt(4) lgkmcnt(15)
    v_mfma_f32_16x16x32_bf16 v[96:99], v[104:107], v[200:203], v[96:99]
    ds_read_b64_tr_b16 v[160:161], v28 offset:20480
    ds_read_b64_tr_b16 v[162:163], v28 offset:20992
    ds_read_b64_tr_b16 v[40:41], v29 offset:20480
    ds_read_b64_tr_b16 v[42:43], v29 offset:20992
    v_mfma_f32_16x16x32_bf16 v[100:103], v[108:111], v[200:203], v[100:103]
    ds_read_b64_tr_b16 v[44:45], v30 offset:20480
    ds_read_b64_tr_b16 v[46:47], v30 offset:20992
    ds_read_b64_tr_b16 v[168:169], v17 offset:20480
    ds_read_b64_tr_b16 v[170:171], v17 offset:20992
    s_waitcnt vmcnt(3) lgkmcnt(15)
    v_mfma_f32_16x16x32_bf16 v[96:99], v[164:167], v[176:179], v[96:99]
    v_mfma_f32_16x16x32_bf16 v[100:103], v[196:199], v[176:179], v[100:103]
    s_cmp_lt_u32 s40, 4
    s_cbranch_scc1 L_ol2
    s_waitcnt vmcnt(1)
    buffer_load_dwordx4 v[64:67], v9, s[32:35], s86 offen sc1
    buffer_load_dwordx4 v[68:71], v9, s[32:35], s87 offen sc1
    buffer_load_dwordx4 v[72:75], v9, s[32:35], s88 offen sc1
    buffer_load_dwordx4 v[76:79], v9, s[32:35], s89 offen sc1
    buffer_load_dwordx4 v[80:83], v9, s[32:35], s90 offen sc1
    buffer_load_dwordx4 v[84:87], v9, s[32:35], s91 offen sc1
    buffer_load_dwordx4 v[88:91], v9, s[32:35], s92 offen sc1
    buffer_load_dwordx4 v[92:95], v9, s[32:35], s93 offen sc1
    s_branch L_ol2j
L_ol2:
    s_waitcnt vmcnt(1)
L_ol2j:
    s_waitcnt vmcnt(41) lgkmcnt(15)
    v_mfma_f32_16x16x32_bf16 v[96:99], v[128:131], v[208:211], v[96:99]
    v_mfma_f32_16x16x32_bf16 v[100:103], v[204:207], v[208:211], v[100:103]
    s_waitcnt vmcnt(40) lgkmcnt(15)
    v_mfma_f32_16x16x32_bf16 v[96:99], v[212:215], v[180:183], v[96:99]
    v_mfma_f32_16x16x32_bf16 v[100:103], v[132:135], v[180:183], v[100:103]
    s_nop 6
    v_cvt_pk_bf16_f32 v2, v96, v97
    v_cvt_pk_bf16_f32 v3, v98, v99
    v_cvt_pk_bf16_f32 v4, v100, v101
    v_cvt_pk_bf16_f32 v5, v102, v103
    s_mov_b32 s52, 0
    s_mov_b32 s70, 0
    v_permlane16_swap_b32 v2, v4
    v_permlane16_swap_b32 v3, v5
    buffer_store_dwordx4 v[2:5], v10, s[36:39], 0 offen offset:1024 sc1
    s_cmp_ge_u32 s40, 4
    s_cbranch_scc1 L_ol1
    buffer_load_dwordx4 v[64:67], v9, s[32:35], s86 offen sc1
    buffer_load_dwordx4 v[68:71], v9, s[32:35], s87 offen sc1
    buffer_load_dwordx4 v[72:75], v9, s[32:35], s88 offen sc1
    buffer_load_dwordx4 v[76:79], v9, s[32:35], s89 offen sc1
    buffer_load_dwordx4 v[80:83], v9, s[32:35], s90 offen sc1
    buffer_load_dwordx4 v[84:87], v9, s[32:35], s91 offen sc1
    buffer_load_dwordx4 v[88:91], v9, s[32:35], s92 offen sc1
    buffer_load_dwordx4 v[92:95], v9, s[32:35], s93 offen sc1
    buffer_load_dword v19, v18, s[32:35], 0 offen sc1
L_ol1:
    s_waitcnt vmcnt(8) lgkmcnt(15)
    v_max3_u32 v6, v64, v65, v66
    v_max_u32 v6, v6, v67
    v_cmp_eq_u32 vcc, -1, v6
    s_nop 1
L_oa_go0:
    s_cbranch_vccnz L_oa_bad0
    v_mfma_f32_16x16x32_bf16 v[112:115], v[216:219], v[64:67], v[112:115]
    s_waitcnt vmcnt(7) lgkmcnt(15)
    v_max3_u32 v6, v68, v69, v70
    v_mfma_f32_16x16x32_bf16 v[116:119], v[220:223], v[64:67], v[116:119]
    ds_read_b64_tr_b16 v[48:49], v28 offset:24576
    v_max_u32 v6, v6, v71
    v_cmp_eq_u32 vcc, -1, v6
    v_mfma_f32_16x16x32_bf16 v[120:123], v[136:139], v[64:67], v[120:123]
    ds_read_b64_tr_b16 v[50:51], v28 offset:25088
    v_mfma_f32_16x16x32_bf16 v[124:127], v[184:187], v[64:67], v[124:127]
    ds_read_b64_tr_b16 v[52:53], v29 offset:24576
    ds_read_b64_tr_b16 v[54:55], v29 offset:25088
L_oa_go1:
    s_cbranch_vccnz L_oa_bad1
    v_mfma_f32_16x16x32_bf16 v[112:115], v[224:227], v[68:71], v[112:115]
    s_waitcnt vmcnt(6) lgkmcnt(15)
    v_max3_u32 v6, v72, v73, v74
    v_mfma_f32_16x16x32_bf16 v[116:119], v[140:143], v[68:71], v[116:119]
    ds_read_b64_tr_b16 v[192:193], v30 offset:24576
    v_max_u32 v6, v6, v75
    v_cmp_eq_u32 vcc, -1, v6
    v_mfma_f32_16x16x32_bf16 v[120:123], v[228:231], v[68:71], v[120:123]
    ds_read_b64_tr_b16 v[194:195], v30 offset:25088
    v_mfma_f32_16x16x32_bf16 v[124:127], v[188:191], v[68:71], v[124:127]
    ds_read_b64_tr_b16 v[56:57], v17 offset:24576
    ds_read_b64_tr_b16 v[58:59], v17 offset:25088
L_oa_go2:
    s_cbranch_vccnz L_oa_bad2
    v_mfma_f32_16x16x32_bf16 v[112:115], v[144:147], v[72:75], v[112:115]
    s_waitcnt vmcnt(5) lgkmcnt(15)
    v_max3_u32 v6, v76, v77, v78
    v_mfma_f32_16x16x32_bf16 v[116:119], v[232:235], v[72:75], v[116:119]
    ds_read_b64_tr_b16 v[60:61], v28 offset:28672
    v_max_u32 v6, v6, v79
    v_cmp_eq_u32 vcc, -1, v6
    v_mfma_f32_16x16x32_bf16 v[120:123], v[236:239], v[72:75], v[120:123]
    ds_read_b64_tr_b16 v[62:63], v28 offset:29184
    v_mfma_f32_16x16x32_bf16 v[124:127], v[148:151], v[72:75], v[124:127]
    ds_read_b64_tr_b16 v[172:173], v29 offset:28672
    ds_read_b64_tr_b16 v[174:175], v29 offset:29184
L_oa_go3:
    s_cbranch_vccnz L_oa_bad3
    v_mfma_f32_16x16x32_bf16 v[112:115], v[240:243], v[76:79], v[112:115]
    s_waitcnt vmcnt(4) lgkmcnt(15)
    v_max3_u32 v6, v80, v81, v82
    v_mfma_f32_16x16x32_bf16 v[116:119], v[244:247], v[76:79], v[116:119]
    ds_read_b64_tr_b16 v[104:105], v30 offset:28672
    v_max_u32 v6, v6, v83
    v_cmp_eq_u32 vcc, -1, v6
    v_mfma_f32_16x16x32_bf16 v[120:123], v[152:155], v[76:79], v[120:123]
    ds_read_b64_tr_b16 v[106:107], v30 offset:29184
    v_mfma_f32_16x16x32_bf16 v[124:127], v[248:251], v[76:79], v[124:127]
    ds_read_b64_tr_b16 v[108:109], v17 offset:28672
    ds_read_b64_tr_b16 v[110:111], v17 offset:29184
L_oa_go4:
    s_cbranch_vccnz L_oa_bad4
    v_mfma_f32_16x16x32_bf16 v[112:115], v[252:255], v[80:83], v[112:115]
    s_waitcnt vmcnt(3) lgkmcnt(15)
    v_max3_u32 v6, v84, v85, v86
    v_mfma_f32_16x16x32_bf16 v[116:119], v[156:159], v[80:83], v[116:119]
    v_max_u32 v6, v6, v87
    v_cmp_eq_u32 vcc, -1, v6
    v_mfma_f32_16x16x32_bf16 v[120:123], v[32:35], v[80:83], v[120:123]
    v_mfma_f32_16x16x32_bf16 v[124:127], v[36:39], v[80:83], v[124:127]
L_oa_go5:
    s_cbranch_vccnz L_oa_bad5
    v_mfma_f32_16x16x32_bf16 v[112:115], v[160:163], v[84:87], v[112:115]
    s_waitcnt vmcnt(2) lgkmcnt(8)
    v_max3_u32 v6, v88, v89, v90
    v_mfma_f32_16x16x32_bf16 v[116:119], v[40:43], v[84:87], v[116:119]
    v_max_u32 v6, v6, v91
    v_cmp_eq_u32 vcc, -1, v6
    v_mfma_f32_16x16x32_bf16 v[120:123], v[44:47], v[84:87], v[120:123]
    v_mfma_f32_16x16x32_bf16 v[124:127], v[168:171], v[84:87], v[124:127]
L_oa_go6:
    s_cbranch_vccnz L_oa_bad6
    v_mfma_f32_16x16x32_bf16 v[112:115], v[48:51], v[88:91], v[112:115]
    s_waitcnt vmcnt(1) lgkmcnt(0)
    v_max3_u32 v6, v92, v93, v94
    v_mfma_f32_16x16x32_bf16 v[116:119], v[52:55], v[88:91], v[116:119]
    v_max_u32 v6, v6, v95
    v_cmp_eq_u32 vcc, -1, v6
    v_mfma_f32_16x16x32_bf16 v[120:123], v[192:195], v[88:91], v[120:123]
    v_mfma_f32_16x16x32_bf16 v[124:127], v[56:59], v[88:91], v[124:127]
L_oa_go7:
    s_cbranch_vccnz L_oa_bad7
    v_mfma_f32_16x16x32_bf16 v[120:123], v[104:107], v[92:95], v[120:123]
    v_mfma_f32_16x16x32_bf16 v[124:127], v[108:111], v[92:95], v[124:127]
    v_mfma_f32_16x16x32_bf16 v[112:115], v[60:63], v[92:95], v[112:115]
    v_mfma_f32_16x16x32_bf16 v[116:119], v[172:175], v[92:95], v[116:119]
L_oa_go8:
    s_cmp_lg_u32 s52, 0
    s_cbranch_scc1 L_oa_retry
L_oa_done:
    s_nop 2
    ds_write_b128 v21, v[120:123] offset:0
    ds_write_b128 v21, v[124:127] offset:8192
    ds_write_b32 v21, v31 offset:16392
    s_mov_b32 s70, 0
L_pw:
    ds_read_b32 v6, v20 offset:16392
    ds_read_b128 v[64:67], v20 offset:0
    ds_read_b128 v[68:71], v20 offset:8192
    s_add_u32 s70, s70, 1
    s_cmp_gt_u32 s70, 1048576
    s_waitcnt lgkmcnt(2)
    v_cmp_eq_u32 vcc, 0, v6
    s_cbranch_scc1 L_pw_x
    s_nop 0
    s_cbranch_vccnz L_pw
L_pw_x:
    s_or_b32 s50, s2, s40
    s_cbranch_scc0 L_epoch
L_epoch_ret:
    s_waitcnt lgkmcnt(1)
    v_pk_add_f32 v[112:113], v[112:113], v[64:65]
    v_pk_add_f32 v[114:115], v[114:115], v[66:67]
    v_cvt_pk_bf16_f32 v96, v112, v113
    v_cvt_pk_bf16_f32 v97, v114, v115
    s_waitcnt lgkmcnt(0)
    v_pk_add_f32 v[116:117], v[116:117], v[68:69]
    v_pk_add_f32 v[118:119], v[118:119], v[70:71]
    v_cvt_pk_bf16_f32 v98, v116, v117
    v_cvt_pk_bf16_f32 v99, v118, v119
    s_nop 0
    v_permlane16_swap_b32 v96, v98
    v_permlane16_swap_b32 v97, v99
    buffer_store_dwordx4 v[96:99], v10, s[36:39], 0 offen sc1
L_end:
    s_endpgm
L_epoch:
    s_mov_b32 s50, 10485760
    v_mov_b32 v1, 0
    v_mov_b32 v2, s49
    s_mov_b64 exec, 1
    buffer_store_dword v2, v1, s[32:35], s50 offen sc1
    s_mov_b64 exec, -1
    s_branch L_epoch_ret
L_oa_bad0:
    buffer_load_dwordx4 v[64:67], v9, s[32:35], s86 offen sc1
    s_or_b32 s52, s52, 1
    s_waitcnt vmcnt(7) lgkmcnt(15)
    v_max3_u32 v6, v68, v69, v70
    v_max_u32 v6, v6, v71
    v_cmp_eq_u32 vcc, -1, v6
    ds_read_b64_tr_b16 v[48:49], v28 offset:24576
    ds_read_b64_tr_b16 v[50:51], v28 offset:25088
    ds_read_b64_tr_b16 v[52:53], v29 offset:24576
    ds_read_b64_tr_b16 v[54:55], v29 offset:25088
    s_nop 0
    s_branch L_oa_go1
L_oa_bad1:
    buffer_load_dwordx4 v[68:71], v9, s[32:35], s87 offen sc1
    s_or_b32 s52, s52, 2
    s_waitcnt vmcnt(6) lgkmcnt(15)
    v_max3_u32 v6, v72, v73, v74
    v_max_u32 v6, v6, v75
    v_cmp_eq_u32 vcc, -1, v6
    ds_read_b64_tr_b16 v[192:193], v30 offset:24576
    ds_read_b64_tr_b16 v[194:195], v30 offset:25088
    ds_read_b64_tr_b16 v[56:57], v17 offset:24576
    ds_read_b64_tr_b16 v[58:59], v17 offset:25088
    s_nop 0
    s_branch L_oa_go2
L_oa_bad2:
    buffer_load_dwordx4 v[72:75], v9, s[32:35], s88 offen sc1
    s_or_b32 s52, s52, 4
    s_waitcnt vmcnt(5) lgkmcnt(15)
    v_max3_u32 v6, v76, v77, v78
    v_max_u32 v6, v6, v79
    v_cmp_eq_u32 vcc, -1, v6
    ds_read_b64_tr_b16 v[60:61], v28 offset:28672
    ds_read_b64_tr_b16 v[62:63], v28 offset:29184
    ds_read_b64_tr_b16 v[172:173], v29 offset:28672
    ds_read_b64_tr_b16 v[174:175], v29 offset:29184
    s_nop 0
    s_branch L_oa_go3
L_oa_bad3:
    buffer_load_dwordx4 v[76:79], v9, s[32:35], s89 offen sc1
    s_or_b32 s52, s52, 8
    s_waitcnt vmcnt(4) lgkmcnt(15)
    v_max3_u32 v6, v80, v81, v82
    v_max_u32 v6, v6, v83
    v_cmp_eq_u32 vcc, -1, v6
    ds_read_b64_tr_b16 v[104:105], v30 offset:28672
    ds_read_b64_tr_b16 v[106:107], v30 offset:29184
    ds_read_b64_tr_b16 v[108:109], v17 offset:28672
    ds_read_b64_tr_b16 v[110:111], v17 offset:29184
    s_nop 0
    s_branch L_oa_go4
L_oa_bad4:
    buffer_load_dwordx4 v[80:83], v9, s[32:35], s90 offen sc1
    s_or_b32 s52, s52, 16
    s_waitcnt vmcnt(3) lgkmcnt(15)
    v_max3_u32 v6, v84, v85, v86
    v_max_u32 v6, v6, v87
    v_cmp_eq_u32 vcc, -1, v6
    s_nop 0
    s_branch L_oa_go5
L_oa_bad5:
    buffer_load_dwordx4 v[84:87], v9, s[32:35], s91 offen sc1
    s_or_b32 s52, s52, 32
    s_waitcnt vmcnt(2) lgkmcnt(8)
    v_max3_u32 v6, v88, v89, v90
    v_max_u32 v6, v6, v91
    v_cmp_eq_u32 vcc, -1, v6
    s_nop 0
    s_branch L_oa_go6
L_oa_bad6:
    buffer_load_dwordx4 v[88:91], v9, s[32:35], s92 offen sc1
    s_or_b32 s52, s52, 64
    s_waitcnt vmcnt(1) lgkmcnt(0)
    v_max3_u32 v6, v92, v93, v94
    v_max_u32 v6, v6, v95
    v_cmp_eq_u32 vcc, -1, v6
    s_nop 0
    s_branch L_oa_go7
L_oa_bad7:
    buffer_load_dwordx4 v[92:95], v9, s[32:35], s93 offen sc1
    s_or_b32 s52, s52, 128
    s_branch L_oa_go8
L_oa_retry:
    s_add_u32 s70, s70, 1
    s_cmp_gt_u32 s70, 65536
    s_waitcnt vmcnt(0)
    s_cbranch_scc1 L_oa_done
    s_bitcmp1_b32 s52, 0
    s_cbranch_scc0 L_oa_c0
    v_max3_u32 v6, v64, v65, v66
    v_max_u32 v6, v6, v67
    v_cmp_eq_u32 vcc, -1, v6
    s_nop 1
    s_cbranch_vccnz L_oa_r0
    v_mfma_f32_16x16x32_bf16 v[112:115], v[216:219], v[64:67], v[112:115]
    v_mfma_f32_16x16x32_bf16 v[116:119], v[220:223], v[64:67], v[116:119]
    v_mfma_f32_16x16x32_bf16 v[120:123], v[136:139], v[64:67], v[120:123]
    v_mfma_f32_16x16x32_bf16 v[124:127], v[184:187], v[64:67], v[124:127]
    s_and_b32 s52, s52, 254
    s_branch L_oa_c0
L_oa_r0:
    buffer_load_dwordx4 v[64:67], v9, s[32:35], s86 offen sc1
L_oa_c0:
    s_bitcmp1_b32 s52, 1
    s_cbranch_scc0 L_oa_c1
    v_max3_u32 v6, v68, v69, v70
    v_max_u32 v6, v6, v71
    v_cmp_eq_u32 vcc, -1, v6
    s_nop 1
    s_cbranch_vccnz L_oa_r1
    v_mfma_f32_16x16x32_bf16 v[112:115], v[224:227], v[68:71], v[112:115]
    v_mfma_f32_16x16x32_bf16 v[116:119], v[140:143], v[68:71], v[116:119]
    v_mfma_f32_16x16x32_bf16 v[120:123], v[228:231], v[68:71], v[120:123]
    v_mfma_f32_16x16x32_bf16 v[124:127], v[188:191], v[68:71], v[124:127]
    s_and_b32 s52, s52, 253
    s_branch L_oa_c1
L_oa_r1:
    buffer_load_dwordx4 v[68:71], v9, s[32:35], s87 offen sc1
L_oa_c1:
    s_bitcmp1_b32 s52, 2
    s_cbranch_scc0 L_oa_c2
    v_max3_u32 v6, v72, v73, v74
    v_max_u32 v6, v6, v75
    v_cmp_eq_u32 vcc, -1, v6
    s_nop 1
    s_cbranch_vccnz L_oa_r2
    v_mfma_f32_16x16x32_bf16 v[112:115], v[144:147], v[72:75], v[112:115]
    v_mfma_f32_16x16x32_bf16 v[116:119], v[232:235], v[72:75], v[116:119]
    v_mfma_f32_16x16x32_bf16 v[120:123], v[236:239], v[72:75], v[120:123]
    v_mfma_f32_16x16x32_bf16 v[124:127], v[148:151], v[72:75], v[124:127]
    s_and_b32 s52, s52, 251
    s_branch L_oa_c2
L_oa_r2:
    buffer_load_dwordx4 v[72:75], v9, s[32:35], s88 offen sc1
L_oa_c2:
    s_bitcmp1_b32 s52, 3
    s_cbranch_scc0 L_oa_c3
    v_max3_u32 v6, v76, v77, v78
    v_max_u32 v6, v6, v79
    v_cmp_eq_u32 vcc, -1, v6
    s_nop 1
    s_cbranch_vccnz L_oa_r3
    v_mfma_f32_16x16x32_bf16 v[112:115], v[240:243], v[76:79], v[112:115]
    v_mfma_f32_16x16x32_bf16 v[116:119], v[244:247], v[76:79], v[116:119]
    v_mfma_f32_16x16x32_bf16 v[120:123], v[152:155], v[76:79], v[120:123]
    v_mfma_f32_16x16x32_bf16 v[124:127], v[248:251], v[76:79], v[124:127]
    s_and_b32 s52, s52, 247
    s_branch L_oa_c3
L_oa_r3:
    buffer_load_dwordx4 v[76:79], v9, s[32:35], s89 offen sc1
L_oa_c3:
    s_bitcmp1_b32 s52, 4
    s_cbranch_scc0 L_oa_c4
    v_max3_u32 v6, v80, v81, v82
    v_max_u32 v6, v6, v83
    v_cmp_eq_u32 vcc, -1, v6
    s_nop 1
    s_cbranch_vccnz L_oa_r4
    v_mfma_f32_16x16x32_bf16 v[112:115], v[252:255], v[80:83], v[112:115]
    v_mfma_f32_16x16x32_bf16 v[116:119], v[156:159], v[80:83], v[116:119]
    v_mfma_f32_16x16x32_bf16 v[120:123], v[32:35], v[80:83], v[120:123]
    v_mfma_f32_16x16x32_bf16 v[124:127], v[36:39], v[80:83], v[124:127]
    s_and_b32 s52, s52, 239
    s_branch L_oa_c4
L_oa_r4:
    buffer_load_dwordx4 v[80:83], v9, s[32:35], s90 offen sc1
L_oa_c4:
    s_bitcmp1_b32 s52, 5
    s_cbranch_scc0 L_oa_c5
    v_max3_u32 v6, v84, v85, v86
    v_max_u32 v6, v6, v87
    v_cmp_eq_u32 vcc, -1, v6
    s_nop 1
    s_cbranch_vccnz L_oa_r5
    v_mfma_f32_16x16x32_bf16 v[112:115], v[160:163], v[84:87], v[112:115]
    v_mfma_f32_16x16x32_bf16 v[116:119], v[40:43], v[84:87], v[116:119]
    v_mfma_f32_16x16x32_bf16 v[120:123], v[44:47], v[84:87], v[120:123]
    v_mfma_f32_16x16x32_bf16 v[124:127], v[168:171], v[84:87], v[124:127]
    s_and_b32 s52, s52, 223
    s_branch L_oa_c5
L_oa_r5:
    buffer_load_dwordx4 v[84:87], v9, s[32:35], s91 offen sc1
L_oa_c5:
    s_bitcmp1_b32 s52, 6
    s_cbranch_scc0 L_oa_c6
    v_max3_u32 v6, v88, v89, v90
    v_max_u32 v6, v6, v91
    v_cmp_eq_u32 vcc, -1, v6
    s_nop 1
    s_cbranch_vccnz L_oa_r6
    v_mfma_f32_16x16x32_bf16 v[112:115], v[48:51], v[88:91], v[112:115]
    v_mfma_f32_16x16x32_bf16 v[116:119], v[52:55], v[88:91], v[116:119]
    v_mfma_f32_16x16x32_bf16 v[120:123], v[192:195], v[88:91], v[120:123]
    v_mfma_f32_16x16x32_bf16 v[124:127], v[56:59], v[88:91], v[124:127]
    s_and_b32 s52, s52, 191
    s_branch L_oa_c6
L_oa_r6:
    buffer_load_dwordx4 v[88:91], v9, s[32:35], s92 offen sc1
L_oa_c6:
    s_bitcmp1_b32 s52, 7
    s_cbranch_scc0 L_oa_c7
    v_max3_u32 v6, v92, v93, v94
    v_max_u32 v6, v6, v95
    v_cmp_eq_u32 vcc, -1, v6
    s_nop 1
    s_cbranch_vccnz L_oa_r7
    v_mfma_f32_16x16x32_bf16 v[112:115], v[60:63], v[92:95], v[112:115]
    v_mfma_f32_16x16x32_bf16 v[116:119], v[172:175], v[92:95], v[116:119]
    v_mfma_f32_16x16x32_bf16 v[120:123], v[104:107], v[92:95], v[120:123]
    v_mfma_f32_16x16x32_bf16 v[124:127], v[108:111], v[92:95], v[124:127]
    s_and_b32 s52, s52, 127
    s_branch L_oa_c7
L_oa_r7:
    buffer_load_dwordx4 v[92:95], v9, s[32:35], s93 offen sc1
L_oa_c7:
    s_cmp_lg_u32 s52, 0
    s_cbranch_scc1 L_oa_retry
    s_branch L_oa_done
L_code_end:
    s_endpgm
.section .rodata,"a"
.p2align 6
.amdhsa_kernel concat_heads__softmax_full_mha__sliding_local_dilated__prompt_kernel
  .amdhsa_next_free_vgpr 256
  .amdhsa_next_free_sgpr 102
  .amdhsa_accum_offset 256
  .amdhsa_group_segment_fixed_size 0
  .amdhsa_kernarg_size 72
  .amdhsa_user_sgpr_count 2
  .amdhsa_user_sgpr_kernarg_segment_ptr 1
  .amdhsa_system_sgpr_workgroup_id_x 1
.end_amdhsa_kernel
```
